```python
import torch

def _softmax(x, axis=-1):
    return torch.softmax(x, dim=axis)
def _gelu(x):
    return torch.nn.functional.gelu(x, approximate="tanh")
def _silu(x):
    return torch.nn.functional.silu(x)
def _sigmoid(x):
    return torch.sigmoid(x)
def _layernorm(x, axis=-1, eps=1e-5):
    m = x.mean(dim=axis, keepdim=True)
    v = x.var(dim=axis, keepdim=True, unbiased=False)
    return (x - m) / torch.sqrt(v + eps)
def _scatter_add(tgt, idx, src, axis=0):
    return tgt.clone().index_add_(axis, idx, src)
def _segment_sum(src, seg, n):
    out = torch.zeros((n,) + src.shape[1:], dtype=src.dtype)
    return out.index_add_(0, seg, src)
def _pad(x, pw):
    flat = tuple(v for pair in reversed(pw) for v in pair)
    return torch.nn.functional.pad(x, flat)

kernel_name = 'parallel_sum__spectral_gfnet__glu_gated_reglu__prompt'

def setup_inputs():

    _w = (lambda a: (lambda t: t.to(torch.bfloat16) if t.is_floating_point() else t)(torch.as_tensor(a)))
    def _A_setup():
        B, S, D = 1, 2048, 512
        Df = D // 2 + 1
        return {
            "x": _w((lambda *s: torch.randn(*s, dtype=torch.bfloat16) * 0.05)(B, S, D)),
            "w_r": _w((lambda *s: torch.randn(*s, dtype=torch.bfloat16) * 0.4)(S, Df) * 0.02),
            "w_i": _w((lambda *s: torch.randn(*s, dtype=torch.bfloat16) * 0.4)(S, Df) * 0.02),
        }
    _A_in = _A_setup()

    def _B_setup():
        B, S, D, F = 1, 2048, 512, 1376
        return {
            "x": _w((lambda *s: torch.randn(*s, dtype=torch.bfloat16) * 0.05)(B, S, D)),
            "W_gate": _w((lambda *s: torch.randn(*s, dtype=torch.bfloat16) * 0.2)(D, F) * (2.0 / D) ** 0.5),
            "W_up": _w((lambda *s: torch.randn(*s, dtype=torch.bfloat16) * 0.2)(D, F) * (2.0 / D) ** 0.5),
            "W_down": _w((lambda *s: torch.randn(*s, dtype=torch.bfloat16) * 0.2)(F, D) * (1.0 / F) ** 0.5),
        }
    _B_in = _B_setup()

    return {
        "A_x": _A_in["x"],
        "A_w_r": _A_in["w_r"],
        "A_w_i": _A_in["w_i"],
        "B_x": _B_in["x"],
        "B_W_gate": _B_in["W_gate"],
        "B_W_up": _B_in["W_up"],
        "B_W_down": _B_in["W_down"],
    }

def reference(A_x, A_w_r, A_w_i, B_x, B_W_gate, B_W_up, B_W_down):
    def _A_ref(x, w_r, w_i):
        B, S, D = x.shape
        X = (lambda x, axes=(-2,-1): torch.fft.rfft2(x.float(), dim=axes))(x, axes=(-2, -1))
        W = w_r + 1j * w_i
        X = X * W
        y = (lambda x, s, axes=(-2,-1): torch.fft.irfft2(x, s=s, dim=axes).to(torch.bfloat16))(X, (S, D), axes=(-2, -1))
        return y

    def _B_ref(x, W_gate, W_up, W_down):
        gate = torch.einsum("bsd,df->bsf", x, W_gate)
        up = torch.einsum("bsd,df->bsf", x, W_up)
        gate = gate * (lambda x, dt: x.to(dt))(gate > 0, gate.dtype)
        h = gate * up
        return torch.einsum("bsf,fd->bsd", h, W_down)

    x = A_x
    xn = _layernorm(x, axis=-1)
    return x + _A_ref(xn, A_w_r, A_w_i) + _B_ref(xn, B_W_gate, B_W_up, B_W_down)
```

```asm
; @launch grid=(256,1,1) block=(512,1,1) lds=147968
.amdgcn_target "amdgcn-amd-amdhsa--gfx950"
.text
.globl parallel_sum__spectral_gfnet__glu_gated_reglu__prompt_kernel
.p2align 8
.type parallel_sum__spectral_gfnet__glu_gated_reglu__prompt_kernel,@function
parallel_sum__spectral_gfnet__glu_gated_reglu__prompt_kernel:
s_cmp_ge_u32 s2, 256
s_cbranch_scc1 L_done
s_load_dwordx4 s[72:75], s[0:1], 0
s_load_dwordx4 s[80:83], s[0:1], 32
s_load_dwordx4 s[88:91], s[0:1], 64
s_load_dwordx2 s[76:77], s[0:1], 16
s_load_dwordx2 s[78:79], s[0:1], 48
s_load_dwordx2 s[84:85], s[0:1], 56
v_lshrrev_b32 v2, 6, v0
v_and_b32 v1, 63, v0
v_readfirstlane_b32 s39, v2
v_and_b32 v9, 31, v0
v_bfe_u32 v10, v0, 5, 1
v_mov_b32 v11, 0
s_and_b32 s56, s2, 7
s_lshr_b32 s57, s2, 3
s_and_b32 s41, s56, 1
s_lshl_b32 s41, s41, 3
s_and_b32 s58, s57, 7
s_add_u32 s41, s41, s58
s_lshr_b32 s42, s56, 1
s_lshl_b32 s42, s42, 2
s_lshr_b32 s58, s57, 3
s_add_u32 s42, s42, s58
s_mul_i32 s43, s42, 174768
s_lshr_b32 s43, s43, 16
s_and_b32 s40, s39, 3
s_lshl_b32 s44, s41, 2
s_add_u32 s44, s44, s40
s_lshr_b32 s45, s40, 1
s_and_b32 s46, s40, 1
s_cmp_lt_u32 s39, 4
s_cbranch_scc1 L_compute
v_lshrrev_b32 v24, 3, v1
v_and_b32 v25, 7, v1
v_lshrrev_b32 v26, 4, v1
v_xor_b32 v25, v25, v26
v_lshlrev_b32 v24, 16, v24
v_lshl_add_u32 v2, v25, 4, v24
v_xor_b32 v3, 64, v2
v_add_u32 v3, 0x80000, v3
v_add_u32 v4, 0x100000, v2
v_add_u32 v5, 0x100000, v3
s_lshl_b32 s47, s44, 10
s_lshl_b32 s51, s40, 12
s_lshr_b32 s38, s41, 1
s_mul_i32 s48, s40, 44032
s_lshl_b32 s56, s43, 6
s_add_u32 s48, s48, s56
s_mul_i32 s60, s40, 3072
s_add_u32 s60, s60, 49152
s_waitcnt lgkmcnt(0)
v_mov_b32 v240, s72
v_mov_b32 v241, s73
v_cmp_eq_u32 vcc, 1, v1
v_mov_b32 v242, s80
v_mov_b32 v243, s81
v_cndmask_b32 v240, v240, v242, vcc
v_cndmask_b32 v241, v241, v243, vcc
v_cmp_eq_u32 vcc, 2, v1
v_mov_b32 v242, s82
v_mov_b32 v243, s83
v_cndmask_b32 v240, v240, v242, vcc
v_cndmask_b32 v241, v241, v243, vcc
v_cmp_eq_u32 vcc, 3, v1
v_mov_b32 v242, s74
v_mov_b32 v243, s75
v_cndmask_b32 v240, v240, v242, vcc
v_cndmask_b32 v241, v241, v243, vcc
v_cmp_eq_u32 vcc, 4, v1
v_mov_b32 v242, s76
v_mov_b32 v243, s77
v_cndmask_b32 v240, v240, v242, vcc
v_cndmask_b32 v241, v241, v243, vcc
v_cmp_eq_u32 vcc, 5, v1
v_mov_b32 v242, s78
v_mov_b32 v243, s79
v_cndmask_b32 v240, v240, v242, vcc
v_cndmask_b32 v241, v241, v243, vcc
s_mov_b64 exec, 63
global_load_dword v251, v[240:241], off
s_mov_b64 exec, -1
s_mov_b32 s8, s72
s_and_b32 s9, s73, 0xffff
s_mov_b32 s10, 2097152
s_mov_b32 s11, 0x20000
s_add_u32 s50, s38, 0
s_and_b32 s50, s50, 7
s_lshl_b32 s49, s50, 7
s_add_u32 s49, s49, s47
s_mul_i32 s50, s50, 176128
s_add_u32 s50, s50, s48
s_add_u32 m0, s51, 0
s_nop 0
buffer_load_dwordx4 v2, s[8:11], s49 offen lds
s_addk_i32 m0, 1024
s_nop 0
buffer_load_dwordx4 v3, s[8:11], s49 offen lds
s_addk_i32 m0, 1024
s_nop 0
buffer_load_dwordx4 v4, s[8:11], s49 offen lds
s_addk_i32 m0, 1024
s_nop 0
buffer_load_dwordx4 v5, s[8:11], s49 offen lds
s_mov_b32 s56, 357913942
s_movk_i32 s57, 2752
v_add_u32 v24, 0, v1
v_mul_hi_u32 v25, v24, s56
v_mul_u32_u24 v26, 12, v25
v_sub_u32 v26, v24, v26
v_mul_u32_u24 v25, s57, v25
v_lshl_add_u32 v6, v26, 4, v25
v_add_u32 v24, 64, v1
v_mul_hi_u32 v25, v24, s56
v_mul_u32_u24 v26, 12, v25
v_sub_u32 v26, v24, v26
v_mul_u32_u24 v25, s57, v25
v_lshl_add_u32 v7, v26, 4, v25
v_add_u32 v24, 128, v1
v_mul_hi_u32 v25, v24, s56
v_mul_u32_u24 v26, 12, v25
v_sub_u32 v26, v24, v26
v_mul_u32_u24 v25, s57, v25
v_lshl_add_u32 v8, v26, 4, v25
s_mov_b32 s12, s80
s_and_b32 s13, s81, 0xffff
s_mov_b32 s14, 1409024
s_mov_b32 s15, 0x20000
s_mov_b32 s16, s82
s_and_b32 s17, s83, 0xffff
s_mov_b32 s18, 1409024
s_mov_b32 s19, 0x20000
s_add_u32 m0, s60, 0
s_nop 0
buffer_load_dwordx4 v6, s[12:15], s50 offen lds
s_addk_i32 m0, 1024
s_nop 0
buffer_load_dwordx4 v7, s[12:15], s50 offen lds
s_addk_i32 m0, 1024
s_nop 0
buffer_load_dwordx4 v8, s[12:15], s50 offen lds
s_add_u32 m0, s60, 12320
s_nop 0
buffer_load_dwordx4 v6, s[16:19], s50 offen lds
s_addk_i32 m0, 1024
s_nop 0
buffer_load_dwordx4 v7, s[16:19], s50 offen lds
s_addk_i32 m0, 1024
s_nop 0
buffer_load_dwordx4 v8, s[16:19], s50 offen lds
s_add_u32 s20, s90, 13631488
s_addc_u32 s21, s91, 0
s_and_b32 s21, s21, 0xffff
s_mov_b32 s22, 2097152
s_mov_b32 s23, 0x20000
s_mov_b32 s52, s88
s_and_b32 s53, s89, 0xffff
s_mov_b32 s54, 256
s_mov_b32 s55, 0x20000
s_or_b32 s56, s2, s40
s_cmp_eq_u32 s56, 0
s_cbranch_scc0 L_non
s_memrealtime s[56:57]
s_waitcnt lgkmcnt(0)
s_or_b32 s56, s56, 1
v_mov_b32 v24, s56
s_mov_b64 exec, 1
buffer_store_dword v24, v11, s[52:55], 0 offen sc1
s_mov_b64 exec, -1
L_non:
s_mov_b32 s37, 0xffff0000
v_lshrrev_b32 v20, 1, v9
s_lshl_b32 s56, s42, 4
v_add_u32 v20, s56, v20
v_and_b32 v25, 1, v9
v_cmp_eq_u32 vcc, 0, v20
v_cmp_eq_u32 s[58:59], 1, v25
s_nop 3
s_and_b64 vcc, vcc, s[58:59]
v_mov_b32 v21, 0x100
v_cndmask_b32 v20, v20, v21, vcc
v_cndmask_b32 v25, v25, 0, vcc
v_cvt_f32_u32 v20, v20
v_mul_f32 v20, 0x3b000000, v20
v_cvt_f32_u32 v25, v25
v_mul_f32 v25, 0x3e800000, v25
s_lshr_b32 s56, s41, 1
s_add_u32 s56, s56, 3
s_and_b32 s56, s56, 7
s_lshl_b32 s56, s56, 6
s_lshl_b32 s57, s40, 4
s_add_u32 s56, s56, s57
v_lshlrev_b32 v21, 3, v10
v_add_u32 v21, s56, v21
v_cvt_f32_u32 v21, v21
v_fma_f32 v21, v20, v21, v25
v_mul_f32 v22, 0x42600000, v20
v_lshlrev_b32 v24, 4, v1
s_lshl_b32 s56, s40, 10
s_add_u32 s56, s56, 122976
v_add_u32 v13, s56, v24
v_and_b32 v12, 255, v0
s_waitcnt vmcnt(0)
s_waitcnt lgkmcnt(0)
s_barrier
s_add_u32 s50, s38, 1
s_and_b32 s50, s50, 7
s_lshl_b32 s49, s50, 7
s_add_u32 s49, s49, s47
s_mul_i32 s50, s50, 176128
s_add_u32 s50, s50, s48
s_add_u32 m0, s51, 16384
s_nop 0
buffer_load_dwordx4 v2, s[8:11], s49 offen lds
buffer_load_dword v17, v11, s[52:55], 0 offen sc1
v_lshrrev_b32 v128, 3, v1
v_mul_u32_u24 v128, 768, v128
v_and_b32 v129, 7, v1
v_lshl_add_u32 v128, v129, 4, v128
s_and_b32 s98, s41, 1
s_mul_i32 s98, s98, 6144
s_addk_i32 m0, 1024
s_nop 0
buffer_load_dwordx4 v3, s[8:11], s49 offen lds
s_mul_i32 s99, s45, 12320
s_add_u32 s98, s98, s99
s_mul_i32 s99, s46, 96
s_add_u32 s98, s98, s99
s_add_u32 s98, s98, 49152
v_add_u32 v128, s98, v128
ds_read_b128 v[80:83], v128 offset:0
ds_read_b128 v[84:87], v128 offset:192
ds_read_b128 v[88:91], v128 offset:384
s_addk_i32 m0, 1024
s_nop 0
buffer_load_dwordx4 v4, s[8:11], s49 offen lds
ds_read_b128 v[92:95], v128 offset:576
s_lshl_b32 s84, s41, 4
s_add_u32 s84, s84, s42
s_waitcnt lgkmcnt(0)
v_lshlrev_b32 v96, 16, v80
v_and_b32 v97, s37, v80
v_lshlrev_b32 v98, 16, v81
v_and_b32 v99, s37, v81
v_lshlrev_b32 v100, 16, v82
s_addk_i32 m0, 1024
s_nop 0
buffer_load_dwordx4 v5, s[8:11], s49 offen lds
v_and_b32 v101, s37, v82
v_lshlrev_b32 v102, 16, v83
v_and_b32 v103, s37, v83
v_lshlrev_b32 v108, 16, v84
v_and_b32 v109, s37, v84
v_add_f32 v96, v96, v108
v_add_f32 v97, v97, v109
s_add_u32 m0, s60, 24608
s_nop 0
buffer_load_dwordx4 v6, s[12:15], s50 offen lds
v_lshlrev_b32 v110, 16, v85
v_and_b32 v111, s37, v85
v_add_f32 v98, v98, v110
v_add_f32 v99, v99, v111
v_lshlrev_b32 v108, 16, v86
v_and_b32 v109, s37, v86
v_add_f32 v100, v100, v108
s_addk_i32 m0, 1024
s_nop 0
buffer_load_dwordx4 v7, s[12:15], s50 offen lds
v_add_f32 v101, v101, v109
v_lshlrev_b32 v110, 16, v87
v_and_b32 v111, s37, v87
v_add_f32 v102, v102, v110
v_add_f32 v103, v103, v111
v_lshlrev_b32 v108, 16, v88
s_addk_i32 m0, 1024
s_nop 0
buffer_load_dwordx4 v8, s[12:15], s50 offen lds
v_and_b32 v109, s37, v88
v_add_f32 v96, v96, v108
v_add_f32 v97, v97, v109
v_lshlrev_b32 v110, 16, v89
v_and_b32 v111, s37, v89
v_add_f32 v98, v98, v110
v_add_f32 v99, v99, v111
s_add_u32 m0, s60, 36928
s_nop 0
buffer_load_dwordx4 v6, s[16:19], s50 offen lds
v_lshlrev_b32 v108, 16, v90
v_and_b32 v109, s37, v90
v_add_f32 v100, v100, v108
v_add_f32 v101, v101, v109
v_lshlrev_b32 v110, 16, v91
v_and_b32 v111, s37, v91
v_add_f32 v102, v102, v110
s_addk_i32 m0, 1024
s_nop 0
buffer_load_dwordx4 v7, s[16:19], s50 offen lds
v_add_f32 v103, v103, v111
v_lshlrev_b32 v108, 16, v92
v_and_b32 v109, s37, v92
v_add_f32 v96, v96, v108
v_add_f32 v97, v97, v109
v_lshlrev_b32 v110, 16, v93
v_and_b32 v111, s37, v93
s_addk_i32 m0, 1024
s_nop 0
buffer_load_dwordx4 v8, s[16:19], s50 offen lds
v_add_f32 v98, v98, v110
v_add_f32 v99, v99, v111
v_lshlrev_b32 v108, 16, v94
v_and_b32 v109, s37, v94
v_add_f32 v100, v100, v108
v_add_f32 v101, v101, v109
v_lshlrev_b32 v110, 16, v95
s_add_u32 s50, s38, 2
s_and_b32 s50, s50, 7
s_lshl_b32 s49, s50, 7
s_add_u32 s49, s49, s47
s_mul_i32 s50, s50, 176128
s_add_u32 s50, s50, s48
s_add_u32 m0, s51, 32768
s_nop 0
buffer_load_dwordx4 v2, s[8:11], s49 offen lds
v_and_b32 v111, s37, v95
v_add_f32 v102, v102, v110
v_add_f32 v103, v103, v111
v_add_f32_dpp v96, v96, v96 row_ror:8 row_mask:0xf bank_mask:0xf
v_add_f32_dpp v97, v97, v97 row_ror:8 row_mask:0xf bank_mask:0xf
v_add_f32_dpp v98, v98, v98 row_ror:8 row_mask:0xf bank_mask:0xf
v_add_f32_dpp v99, v99, v99 row_ror:8 row_mask:0xf bank_mask:0xf
s_addk_i32 m0, 1024
s_nop 0
buffer_load_dwordx4 v3, s[8:11], s49 offen lds
v_add_f32_dpp v100, v100, v100 row_ror:8 row_mask:0xf bank_mask:0xf
v_add_f32_dpp v101, v101, v101 row_ror:8 row_mask:0xf bank_mask:0xf
v_add_f32_dpp v102, v102, v102 row_ror:8 row_mask:0xf bank_mask:0xf
v_add_f32_dpp v103, v103, v103 row_ror:8 row_mask:0xf bank_mask:0xf
v_mov_b32 v108, v96
v_mov_b32 v109, v97
s_addk_i32 m0, 1024
s_nop 0
buffer_load_dwordx4 v4, s[8:11], s49 offen lds
v_mov_b32 v110, v98
v_mov_b32 v111, v99
v_mov_b32 v112, v100
v_mov_b32 v113, v101
v_mov_b32 v114, v102
v_mov_b32 v115, v103
v_permlane16_swap_b32 v96, v108
s_addk_i32 m0, 1024
s_nop 0
buffer_load_dwordx4 v5, s[8:11], s49 offen lds
v_permlane16_swap_b32 v97, v109
v_permlane16_swap_b32 v98, v110
v_permlane16_swap_b32 v99, v111
v_permlane16_swap_b32 v100, v112
v_permlane16_swap_b32 v101, v113
v_permlane16_swap_b32 v102, v114
v_permlane16_swap_b32 v103, v115
s_add_u32 m0, s60, 49216
s_nop 0
buffer_load_dwordx4 v6, s[12:15], s50 offen lds
v_add_f32 v96, v96, v108
v_add_f32 v97, v97, v109
v_add_f32 v98, v98, v110
v_add_f32 v99, v99, v111
v_add_f32 v100, v100, v112
v_add_f32 v101, v101, v113
v_add_f32 v102, v102, v114
s_addk_i32 m0, 1024
s_nop 0
buffer_load_dwordx4 v7, s[12:15], s50 offen lds
v_add_f32 v103, v103, v115
v_mov_b32 v108, v96
v_mov_b32 v109, v97
v_mov_b32 v110, v98
v_mov_b32 v111, v99
v_mov_b32 v112, v100
v_mov_b32 v113, v101
s_addk_i32 m0, 1024
s_nop 0
buffer_load_dwordx4 v8, s[12:15], s50 offen lds
v_mov_b32 v114, v102
v_mov_b32 v115, v103
v_permlane32_swap_b32 v96, v108
v_permlane32_swap_b32 v97, v109
v_permlane32_swap_b32 v98, v110
v_permlane32_swap_b32 v99, v111
v_permlane32_swap_b32 v100, v112
s_add_u32 m0, s60, 61536
s_nop 0
buffer_load_dwordx4 v6, s[16:19], s50 offen lds
v_permlane32_swap_b32 v101, v113
v_permlane32_swap_b32 v102, v114
v_permlane32_swap_b32 v103, v115
v_add_f32 v96, v96, v108
v_add_f32 v97, v97, v109
v_add_f32 v98, v98, v110
s_addk_i32 m0, 1024
s_nop 0
buffer_load_dwordx4 v7, s[16:19], s50 offen lds
v_add_f32 v99, v99, v111
v_add_f32 v100, v100, v112
v_add_f32 v101, v101, v113
v_add_f32 v102, v102, v114
v_add_f32 v103, v103, v115
s_lshl_b32 s98, s42, 4
s_add_u32 s98, s98, s41
s_mul_i32 s98, s98, 768
s_mul_i32 s99, s40, 192
s_addk_i32 m0, 1024
s_nop 0
buffer_load_dwordx4 v8, s[16:19], s50 offen lds
s_add_u32 s98, s98, s99
s_add_u32 s98, s98, 589824
v_lshlrev_b32 v128, 5, v1
s_mov_b64 exec, 0x3f
buffer_store_dwordx4 v[96:99], v128, s[20:23], s98 offen sc1
buffer_store_dwordx4 v[100:103], v128, s[20:23], s98 offen offset:16 sc1
s_mov_b64 exec, -1
s_waitcnt vmcnt(12)
s_waitcnt lgkmcnt(0)
s_barrier
s_add_u32 s50, s38, 3
s_and_b32 s50, s50, 7
s_lshl_b32 s49, s50, 7
s_add_u32 s49, s49, s47
s_mul_i32 s50, s50, 176128
s_add_u32 s50, s50, s48
s_add_u32 m0, s51, 0
s_nop 0
buffer_load_dwordx4 v2, s[8:11], s49 offen lds
v_fract_f32 v21, v21
v_cos_f32 v116, v21
v_add_f32 v21, v21, v20
v_cos_f32 v117, v21
v_add_f32 v21, v21, v20
s_addk_i32 m0, 1024
s_nop 0
buffer_load_dwordx4 v3, s[8:11], s49 offen lds
v_cos_f32 v118, v21
v_add_f32 v21, v21, v20
v_cos_f32 v119, v21
v_add_f32 v21, v21, v20
v_cos_f32 v120, v21
s_addk_i32 m0, 1024
s_nop 0
buffer_load_dwordx4 v4, s[8:11], s49 offen lds
v_add_f32 v21, v21, v20
v_cos_f32 v121, v21
v_add_f32 v21, v21, v20
v_cos_f32 v122, v21
v_add_f32 v21, v21, v20
s_addk_i32 m0, 1024
s_nop 0
buffer_load_dwordx4 v5, s[8:11], s49 offen lds
v_cos_f32 v123, v21
v_add_f32 v21, v21, v20
v_add_f32 v21, v21, v22
v_cvt_pk_bf16_f32 v124, v116, v117
v_cvt_pk_bf16_f32 v125, v118, v119
v_cvt_pk_bf16_f32 v126, v120, v121
s_add_u32 m0, s60, 0
s_nop 0
buffer_load_dwordx4 v6, s[12:15], s50 offen lds
v_cvt_pk_bf16_f32 v127, v122, v123
ds_write_b128 v13, v[124:127] offset:0
s_mov_b32 s62, 2147418112
s_mov_b32 s24, s74
s_and_b32 s25, s75, 0xffff
s_mov_b32 s26, 1052672
s_mov_b32 s27, 0x20000
s_mov_b32 s28, s76
s_and_b32 s29, s77, 0xffff
s_mov_b32 s30, 1052672
s_mov_b32 s31, 0x20000
s_addk_i32 m0, 1024
s_nop 0
buffer_load_dwordx4 v7, s[12:15], s50 offen lds
s_add_u32 s32, s90, 10485760
s_addc_u32 s33, s91, 0
s_and_b32 s33, s33, 0xffff
s_mov_b32 s34, 2113536
s_mov_b32 s35, 0x20000
s_and_b32 s86, s2, 7
s_bfe_u32 s87, s2, 0x10003
s_lshr_b32 s36, s2, 4
s_lshl_b32 s98, s36, 7
s_lshl_b32 s99, s40, 3
s_add_u32 s98, s98, s99
s_lshl_b32 s99, s87, 2
s_add_u32 s98, s98, s99
v_lshrrev_b32 v128, 4, v1
v_lshlrev_b32 v128, 5, v128
s_addk_i32 m0, 1024
s_nop 0
buffer_load_dwordx4 v8, s[12:15], s50 offen lds
v_bfe_u32 v129, v1, 2, 2
v_add_u32 v128, v128, v129
v_add_u32 v128, s98, v128
v_mul_u32_u24 v128, 514, v128
v_and_b32 v129, 3, v1
v_lshl_add_u32 v128, v129, 4, v128
s_lshl_b32 s99, s86, 6
s_add_u32 m0, s60, 12320
s_nop 0
buffer_load_dwordx4 v6, s[16:19], s50 offen lds
v_add_u32 v16, s99, v128
v_bfe_u32 v128, v1, 4, 1
s_lshl_b32 s98, s86, 1
v_add_u32 v128, s98, v128
v_lshrrev_b32 v129, 2, v128
v_lshlrev_b32 v129, 3, v129
v_and_b32 v128, 3, v128
v_add_u32 v128, v128, v129
s_addk_i32 m0, 1024
s_nop 0
buffer_load_dwordx4 v7, s[16:19], s50 offen lds
v_bfe_u32 v129, v1, 2, 2
v_lshl_add_u32 v128, v129, 5, v128
s_lshl_b32 s98, s36, 7
s_lshl_b32 s99, s87, 2
s_add_u32 s98, s98, s99
v_add_u32 v128, s98, v128
v_sub_u32 v129, 0x800, v128
v_and_b32 v129, 0x7ff, v129
v_and_b32 v130, 1, v1
s_addk_i32 m0, 1024
s_nop 0
buffer_load_dwordx4 v8, s[16:19], s50 offen lds
v_cmp_eq_u32 vcc, 1, v130
s_nop 1
v_cndmask_b32 v128, v128, v129, vcc
v_mul_u32_u24 v128, 514, v128
v_bfe_u32 v130, v1, 1, 1
v_lshlrev_b32 v130, 9, v130
v_add_u32 v15, v128, v130
s_cmp_eq_u32 s40, 3
s_cselect_b32 s67, 0, s62
s_waitcnt vmcnt(12)
s_waitcnt vmcnt(10)
s_waitcnt lgkmcnt(0)
s_barrier
v_readfirstlane_b32 s66, v17
s_nop 3
s_cmp_eq_u32 s66, 0
s_cbranch_scc1 L_ng
L_ng_ret:
s_lshl_b32 s98, s84, 7
s_add_u32 s98, s98, 786432
s_cmp_eq_u32 s40, 0
s_cselect_b32 s98, s98, 2147418112
v_mov_b32 v24, s66
s_mov_b64 exec, 1
buffer_store_dword v24, v11, s[20:23], s98 offen sc1
s_mov_b64 exec, -1
s_lshl_b32 s98, s42, 7
s_add_u32 s98, s98, 868352
s_or_b32 s99, s41, s40
s_cmp_eq_u32 s99, 0
s_cselect_b32 s98, s98, 2147418112
s_lshl_b32 s99, s66, 5
v_mov_b32 v24, s99
s_mov_b64 exec, 1
buffer_store_dword v24, v11, s[20:23], s98 offen sc1
s_mov_b64 exec, -1
s_add_u32 s50, s38, 4
s_and_b32 s50, s50, 7
s_lshl_b32 s49, s50, 7
s_add_u32 s49, s49, s47
s_mul_i32 s50, s50, 176128
s_add_u32 s50, s50, s48
s_add_u32 m0, s51, 16384
s_nop 0
buffer_load_dwordx4 v2, s[8:11], s49 offen lds
v_fract_f32 v21, v21
v_cos_f32 v116, v21
s_addk_i32 m0, 1024
s_nop 0
buffer_load_dwordx4 v3, s[8:11], s49 offen lds
v_add_f32 v21, v21, v20
v_cos_f32 v117, v21
s_addk_i32 m0, 1024
s_nop 0
buffer_load_dwordx4 v4, s[8:11], s49 offen lds
v_add_f32 v21, v21, v20
v_cos_f32 v118, v21
s_addk_i32 m0, 1024
s_nop 0
buffer_load_dwordx4 v5, s[8:11], s49 offen lds
v_add_f32 v21, v21, v20
v_cos_f32 v119, v21
s_add_u32 m0, s60, 24608
s_nop 0
buffer_load_dwordx4 v6, s[12:15], s50 offen lds
v_add_f32 v21, v21, v20
v_cos_f32 v120, v21
v_add_f32 v21, v21, v20
s_addk_i32 m0, 1024
s_nop 0
buffer_load_dwordx4 v7, s[12:15], s50 offen lds
v_cos_f32 v121, v21
v_add_f32 v21, v21, v20
s_addk_i32 m0, 1024
s_nop 0
buffer_load_dwordx4 v8, s[12:15], s50 offen lds
v_cos_f32 v122, v21
v_add_f32 v21, v21, v20
s_add_u32 m0, s60, 36928
s_nop 0
buffer_load_dwordx4 v6, s[16:19], s50 offen lds
v_cos_f32 v123, v21
v_add_f32 v21, v21, v20
s_addk_i32 m0, 1024
s_nop 0
buffer_load_dwordx4 v7, s[16:19], s50 offen lds
v_add_f32 v21, v21, v22
v_cvt_pk_bf16_f32 v124, v116, v117
v_cvt_pk_bf16_f32 v125, v118, v119
s_addk_i32 m0, 1024
s_nop 0
buffer_load_dwordx4 v8, s[16:19], s50 offen lds
v_cvt_pk_bf16_f32 v126, v120, v121
v_cvt_pk_bf16_f32 v127, v122, v123
ds_write_b128 v13, v[124:127] offset:4096
s_waitcnt vmcnt(12)
s_waitcnt lgkmcnt(0)
s_barrier
s_add_u32 s50, s38, 5
s_and_b32 s50, s50, 7
s_lshl_b32 s49, s50, 7
s_add_u32 s49, s49, s47
s_mul_i32 s50, s50, 176128
s_add_u32 s50, s50, s48
s_add_u32 m0, s51, 32768
s_nop 0
buffer_load_dwordx4 v2, s[8:11], s49 offen lds
v_fract_f32 v21, v21
v_cos_f32 v116, v21
s_addk_i32 m0, 1024
s_nop 0
buffer_load_dwordx4 v3, s[8:11], s49 offen lds
v_add_f32 v21, v21, v20
v_cos_f32 v117, v21
s_addk_i32 m0, 1024
s_nop 0
buffer_load_dwordx4 v4, s[8:11], s49 offen lds
v_add_f32 v21, v21, v20
v_cos_f32 v118, v21
s_addk_i32 m0, 1024
s_nop 0
buffer_load_dwordx4 v5, s[8:11], s49 offen lds
v_add_f32 v21, v21, v20
v_cos_f32 v119, v21
s_add_u32 m0, s60, 49216
s_nop 0
buffer_load_dwordx4 v6, s[12:15], s50 offen lds
v_add_f32 v21, v21, v20
v_cos_f32 v120, v21
v_add_f32 v21, v21, v20
s_addk_i32 m0, 1024
s_nop 0
buffer_load_dwordx4 v7, s[12:15], s50 offen lds
v_cos_f32 v121, v21
v_add_f32 v21, v21, v20
s_addk_i32 m0, 1024
s_nop 0
buffer_load_dwordx4 v8, s[12:15], s50 offen lds
v_cos_f32 v122, v21
v_add_f32 v21, v21, v20
s_add_u32 m0, s60, 61536
s_nop 0
buffer_load_dwordx4 v6, s[16:19], s50 offen lds
v_cos_f32 v123, v21
v_add_f32 v21, v21, v20
s_addk_i32 m0, 1024
s_nop 0
buffer_load_dwordx4 v7, s[16:19], s50 offen lds
v_add_f32 v21, v21, v22
v_cvt_pk_bf16_f32 v124, v116, v117
v_cvt_pk_bf16_f32 v125, v118, v119
s_addk_i32 m0, 1024
s_nop 0
buffer_load_dwordx4 v8, s[16:19], s50 offen lds
v_cvt_pk_bf16_f32 v126, v120, v121
v_cvt_pk_bf16_f32 v127, v122, v123
ds_write_b128 v13, v[124:127] offset:8192
s_lshl_b32 s61, s40, 11
s_add_u32 m0, s61, 138848
s_nop 0
buffer_load_dwordx4 v16, s[24:27], 0 offen lds
s_addk_i32 m0, 1024
s_nop 0
buffer_load_dwordx4 v16, s[28:31], 0 offen lds
s_mov_b32 exec_hi, 0
buffer_load_ushort v32, v15, s[24:27], s67 offen
buffer_load_ushort v33, v15, s[28:31], s67 offen
s_mov_b32 exec_hi, -1
s_waitcnt vmcnt(14)
s_waitcnt lgkmcnt(0)
s_barrier
s_add_u32 s50, s38, 6
s_and_b32 s50, s50, 7
s_lshl_b32 s49, s50, 7
s_add_u32 s49, s49, s47
s_mul_i32 s50, s50, 176128
s_add_u32 s50, s50, s48
s_add_u32 m0, s51, 0
s_nop 0
buffer_load_dwordx4 v2, s[8:11], s49 offen lds
v_fract_f32 v21, v21
v_cos_f32 v116, v21
v_add_f32 v21, v21, v20
s_addk_i32 m0, 1024
s_nop 0
buffer_load_dwordx4 v3, s[8:11], s49 offen lds
v_cos_f32 v117, v21
v_add_f32 v21, v21, v20
v_cos_f32 v118, v21
s_addk_i32 m0, 1024
s_nop 0
buffer_load_dwordx4 v4, s[8:11], s49 offen lds
v_add_f32 v21, v21, v20
v_cos_f32 v119, v21
s_addk_i32 m0, 1024
s_nop 0
buffer_load_dwordx4 v5, s[8:11], s49 offen lds
v_add_f32 v21, v21, v20
v_cos_f32 v120, v21
v_add_f32 v21, v21, v20
s_add_u32 m0, s60, 0
s_nop 0
buffer_load_dwordx4 v6, s[12:15], s50 offen lds
v_cos_f32 v121, v21
v_add_f32 v21, v21, v20
v_cos_f32 v122, v21
s_addk_i32 m0, 1024
s_nop 0
buffer_load_dwordx4 v7, s[12:15], s50 offen lds
v_add_f32 v21, v21, v20
v_cos_f32 v123, v21
s_addk_i32 m0, 1024
s_nop 0
buffer_load_dwordx4 v8, s[12:15], s50 offen lds
v_add_f32 v21, v21, v20
v_add_f32 v21, v21, v22
v_cvt_pk_bf16_f32 v124, v116, v117
v_cvt_pk_bf16_f32 v125, v118, v119
s_add_u32 m0, s60, 12320
s_nop 0
buffer_load_dwordx4 v6, s[16:19], s50 offen lds
v_cvt_pk_bf16_f32 v126, v120, v121
v_cvt_pk_bf16_f32 v127, v122, v123
ds_write_b128 v13, v[124:127] offset:0
v_and_b32 v128, 15, v1
s_lshl_b32 s98, s41, 4
s_addk_i32 m0, 1024
s_nop 0
buffer_load_dwordx4 v7, s[16:19], s50 offen lds
v_add_u32 v129, s98, v128
v_lshlrev_b32 v128, 4, v128
v_add_u32 v128, s42, v128
v_bfe_u32 v130, v1, 4, 1
s_addk_i32 m0, 1024
s_nop 0
buffer_load_dwordx4 v8, s[16:19], s50 offen lds
v_cmp_eq_u32 vcc, 0, v130
s_nop 1
v_cndmask_b32 v128, v128, v129, vcc
v_lshlrev_b32 v19, 7, v128
v_add_u32 v19, 786432, v19
s_waitcnt vmcnt(14)
s_waitcnt lgkmcnt(0)
s_barrier
buffer_load_dword v18, v19, s[20:23], 0 offen sc1
s_add_u32 s50, s38, 7
s_and_b32 s50, s50, 7
s_lshl_b32 s49, s50, 7
s_add_u32 s49, s49, s47
s_mul_i32 s50, s50, 176128
s_add_u32 s50, s50, s48
s_add_u32 m0, s51, 16384
s_nop 0
buffer_load_dwordx4 v2, s[8:11], s49 offen lds
v_fract_f32 v21, v21
v_cos_f32 v116, v21
s_addk_i32 m0, 1024
s_nop 0
buffer_load_dwordx4 v3, s[8:11], s49 offen lds
v_add_f32 v21, v21, v20
v_cos_f32 v117, v21
s_addk_i32 m0, 1024
s_nop 0
buffer_load_dwordx4 v4, s[8:11], s49 offen lds
v_add_f32 v21, v21, v20
v_cos_f32 v118, v21
s_addk_i32 m0, 1024
s_nop 0
buffer_load_dwordx4 v5, s[8:11], s49 offen lds
v_add_f32 v21, v21, v20
v_cos_f32 v119, v21
s_add_u32 m0, s60, 24608
s_nop 0
buffer_load_dwordx4 v6, s[12:15], s50 offen lds
v_add_f32 v21, v21, v20
v_cos_f32 v120, v21
v_add_f32 v21, v21, v20
s_addk_i32 m0, 1024
s_nop 0
buffer_load_dwordx4 v7, s[12:15], s50 offen lds
v_cos_f32 v121, v21
v_add_f32 v21, v21, v20
s_addk_i32 m0, 1024
s_nop 0
buffer_load_dwordx4 v8, s[12:15], s50 offen lds
v_cos_f32 v122, v21
v_add_f32 v21, v21, v20
s_add_u32 m0, s60, 36928
s_nop 0
buffer_load_dwordx4 v6, s[16:19], s50 offen lds
v_cos_f32 v123, v21
v_add_f32 v21, v21, v20
s_addk_i32 m0, 1024
s_nop 0
buffer_load_dwordx4 v7, s[16:19], s50 offen lds
v_add_f32 v21, v21, v22
v_cvt_pk_bf16_f32 v124, v116, v117
v_cvt_pk_bf16_f32 v125, v118, v119
s_addk_i32 m0, 1024
s_nop 0
buffer_load_dwordx4 v8, s[16:19], s50 offen lds
v_cvt_pk_bf16_f32 v126, v120, v121
v_cvt_pk_bf16_f32 v127, v122, v123
ds_write_b128 v13, v[124:127] offset:4096
s_waitcnt vmcnt(11)
s_waitcnt lgkmcnt(0)
s_barrier
s_lshl_b32 s98, s40, 2
s_lshl_b32 s99, s41, 4
s_add_u32 s98, s98, s99
s_lshl_b32 s98, s98, 7
s_add_u32 s98, s98, 524288
v_lshrrev_b32 v130, 3, v9
v_lshlrev_b32 v130, 7, v130
v_and_b32 v129, 7, v9
v_lshl_add_u32 v130, v129, 3, v130
v_lshrrev_b32 v14, 4, v1
v_mul_u32_u24 v14, 768, v14
v_and_b32 v129, 15, v1
v_lshl_add_u32 v14, v129, 4, v14
s_mul_i32 s99, s42, 12288
s_lshl_b32 s61, s40, 8
s_add_u32 s99, s99, s61
s_add_u32 s99, s99, 589824
s_cmp_eq_u32 s40, 3
s_cselect_b32 s99, 2147418112, s99
s_lshl_b32 s61, s40, 12
s_waitcnt vmcnt(10)
v_cmp_ne_u32 vcc, s66, v18
s_nop 3
s_cmp_lg_u64 vcc, 0
s_cbranch_scc1 L_spin1
L_spin1_ret:
buffer_load_dwordx2 v[126:127], v130, s[20:23], s98 offen sc1
s_add_u32 m0, s61, 32768
s_nop 0
buffer_load_dwordx4 v14, s[20:23], s99 offen sc1 lds
s_addk_i32 m0, 1024
s_addk_i32 s99, 3072
buffer_load_dwordx4 v14, s[20:23], s99 offen sc1 lds
s_addk_i32 m0, 1024
s_addk_i32 s99, 3072
buffer_load_dwordx4 v14, s[20:23], s99 offen sc1 lds
s_addk_i32 m0, 1024
s_addk_i32 s99, 3072
buffer_load_dwordx4 v14, s[20:23], s99 offen sc1 lds
v_and_b32 v108, 3, v1
v_lshlrev_b32 v108, 6, v108
v_lshrrev_b32 v109, 2, v1
v_lshl_add_u32 v108, v109, 1, v108
s_lshl_b32 s98, s40, 11
s_add_u32 s98, s98, 138848
v_add_u32 v108, s98, v108
ds_read_u16 v144, v108 offset:0
ds_read_u16 v148, v108 offset:1024
ds_read_u16 v145, v108 offset:256
ds_read_u16 v149, v108 offset:1280
ds_read_u16 v146, v108 offset:512
ds_read_u16 v150, v108 offset:1536
ds_read_u16 v147, v108 offset:768
ds_read_u16 v151, v108 offset:1792
ds_read_u16 v152, v108 offset:32
ds_read_u16 v156, v108 offset:1056
ds_read_u16 v153, v108 offset:288
ds_read_u16 v157, v108 offset:1312
ds_read_u16 v154, v108 offset:544
ds_read_u16 v158, v108 offset:1568
ds_read_u16 v155, v108 offset:800
ds_read_u16 v159, v108 offset:1824
s_lshl_b32 s98, s86, 18
s_lshl_b32 s99, s36, 9
s_add_u32 s98, s98, s99
s_lshl_b32 s99, s87, 8
s_add_u32 s98, s98, s99
s_lshl_b32 s99, s40, 6
s_add_u32 s98, s98, s99
v_lshlrev_b32 v108, 13, v109
v_and_b32 v109, 3, v1
v_lshl_add_u32 v108, v109, 4, v108
s_add_u32 s99, s98, 131072
s_waitcnt lgkmcnt(0)
v_lshl_or_b32 v56, v148, 16, v144
v_lshl_or_b32 v57, v149, 16, v145
v_lshl_or_b32 v58, v150, 16, v146
v_lshl_or_b32 v59, v151, 16, v147
v_lshl_or_b32 v60, v156, 16, v152
v_lshl_or_b32 v61, v157, 16, v153
v_lshl_or_b32 v62, v158, 16, v154
v_lshl_or_b32 v63, v159, 16, v155
buffer_store_dwordx4 v[56:59], v108, s[32:35], s98 offen sc1
buffer_store_dwordx4 v[60:63], v108, s[32:35], s99 offen sc1
v_lshlrev_b32 v32, 16, v32
v_lshlrev_b32 v33, 16, v33
v_and_b32 v110, 1, v1
v_lshlrev_b32 v110, 31, v110
v_bfe_u32 v111, v1, 1, 1
v_lshlrev_b32 v111, 31, v111
v_xor_b32 v112, v32, v111
v_xor_b32 v113, v33, v110
v_xor_b32 v114, v113, v111
v_add_f32_dpp v32, v32, v32 quad_perm:[1,0,3,2] row_mask:0xf bank_mask:0xf
v_add_f32_dpp v112, v112, v112 quad_perm:[1,0,3,2] row_mask:0xf bank_mask:0xf
v_add_f32_dpp v113, v113, v113 quad_perm:[1,0,3,2] row_mask:0xf bank_mask:0xf
v_add_f32_dpp v114, v114, v114 quad_perm:[1,0,3,2] row_mask:0xf bank_mask:0xf
v_add_f32_dpp v32, v32, v32 quad_perm:[2,3,0,1] row_mask:0xf bank_mask:0xf
v_add_f32_dpp v112, v112, v112 quad_perm:[2,3,0,1] row_mask:0xf bank_mask:0xf
v_add_f32_dpp v113, v113, v113 quad_perm:[2,3,0,1] row_mask:0xf bank_mask:0xf
v_add_f32_dpp v114, v114, v114 quad_perm:[2,3,0,1] row_mask:0xf bank_mask:0xf
v_mul_f32 v32, 0x3e800000, v32
v_mul_f32 v112, 0x3e800000, v112
v_mul_f32 v113, 0x3e800000, v113
v_mul_f32 v114, 0x3e800000, v114
v_cvt_pk_bf16_f32 v64, v32, v113
v_cvt_pk_bf16_f32 v65, v112, v114
v_lshrrev_b32 v110, 2, v1
v_lshlrev_b32 v110, 2, v110
s_lshl_b32 s98, s36, 9
s_lshl_b32 s99, s87, 8
s_add_u32 s98, s98, s99
s_lshl_b32 s99, s86, 5
s_add_u32 s98, s98, s99
s_add_u32 s98, s98, 2097152
s_add_u32 s98, s98, s67
s_add_u32 s99, s98, 8192
s_mov_b32 exec_lo, 0x11111111
s_mov_b32 exec_hi, 0
buffer_store_dword v65, v110, s[32:35], s98 offen sc1
buffer_store_dword v64, v110, s[32:35], s99 offen sc1
s_mov_b64 exec, -1
s_mov_b32 s68, s78
s_and_b32 s69, s79, 0xffff
s_mov_b32 s70, 1409024
s_mov_b32 s71, 0x20000
s_mul_i32 s98, s2, 5504
s_cmp_eq_u32 s40, 0
s_cselect_b32 s98, s98, 2147418112
v_lshlrev_b32 v129, 7, v1
s_mov_b32 exec_hi, 0x7ff
buffer_load_dword v250, v129, s[68:71], s98 offen
s_mov_b32 exec_hi, -1
s_waitcnt vmcnt(10)
s_waitcnt lgkmcnt(0)
s_barrier
v_lshlrev_b32 v129, 2, v1
s_lshl_b32 s98, s40, 12
s_add_u32 s98, s98, 32768
v_add_u32 v129, s98, v129
s_waitcnt vmcnt(5)
ds_read_b32 v80, v129 offset:0
ds_read_b32 v81, v129 offset:256
ds_read_b32 v82, v129 offset:512
ds_read_b32 v83, v129 offset:768
ds_read_b32 v84, v129 offset:1024
ds_read_b32 v85, v129 offset:1280
ds_read_b32 v86, v129 offset:1536
ds_read_b32 v87, v129 offset:1792
ds_read_b32 v88, v129 offset:2048
ds_read_b32 v89, v129 offset:2304
ds_read_b32 v90, v129 offset:2560
ds_read_b32 v91, v129 offset:2816
ds_read_b32 v92, v129 offset:3072
ds_read_b32 v93, v129 offset:3328
ds_read_b32 v94, v129 offset:3584
ds_read_b32 v95, v129 offset:3840
v_lshlrev_b32 v128, 3, v9
s_lshl_b32 s98, s40, 8
s_add_u32 s98, s98, 137824
v_add_u32 v128, s98, v128
ds_write_b64 v128, v[126:127]
s_waitcnt lgkmcnt(0)
v_add_f32 v80, v80, v88
v_add_f32 v81, v81, v89
v_add_f32 v82, v82, v90
v_add_f32 v83, v83, v91
v_add_f32 v84, v84, v92
v_add_f32 v85, v85, v93
v_add_f32 v86, v86, v94
v_add_f32 v87, v87, v95
v_add_f32 v80, v80, v84
v_add_f32 v81, v81, v85
v_add_f32 v82, v82, v86
v_add_f32 v83, v83, v87
v_add_f32 v80, v80, v82
v_add_f32 v81, v81, v83
v_add_f32 v80, v80, v81
v_cvt_pk_bf16_f32 v131, v80, v80
v_and_b32 v131, s37, v131
v_sub_f32 v130, v80, v131
v_cvt_pk_bf16_f32 v131, v131, v130
v_lshlrev_b32 v128, 2, v12
v_add_u32 v128, 136800, v128
ds_write_b32 v128, v131
s_waitcnt lgkmcnt(0)
s_barrier
s_load_dwordx2 s[80:81], s[0:1], 56
v_and_b32 v14, 15, v0
v_bfe_u32 v13, v0, 4, 2
v_lshrrev_b32 v22, 2, v14
v_lshlrev_b32 v22, 3, v22
v_and_b32 v24, 3, v14
v_add_u32 v229, v22, v24
v_lshlrev_b32 v239, 3, v13
v_cvt_f32_u32 v239, v239
v_cvt_f32_u32 v237, v229
v_mul_f32 v240, 0.5, v239
s_lshl_b32 s56, s40, 4
v_add_u32 v22, s56, v14
v_cvt_f32_u32 v238, v22
v_mul_f32 v23, 0x3d000000, v237
v_mul_f32 v24, v23, v239
v_cos_f32 v28, v24
v_sin_f32 v29, v24
s_nop 0
v_cvt_pk_bf16_f32 v48, v28, v29
v_cvt_pk_bf16_f32 v64, -v29, v28
v_add_f32 v24, v24, v23
v_cos_f32 v28, v24
v_sin_f32 v29, v24
s_nop 0
v_cvt_pk_bf16_f32 v49, v28, v29
v_cvt_pk_bf16_f32 v65, -v29, v28
v_add_f32 v24, v24, v23
v_cos_f32 v28, v24
v_sin_f32 v29, v24
s_nop 0
v_cvt_pk_bf16_f32 v50, v28, v29
v_cvt_pk_bf16_f32 v66, -v29, v28
v_add_f32 v24, v24, v23
v_cos_f32 v28, v24
v_sin_f32 v29, v24
s_nop 0
v_cvt_pk_bf16_f32 v51, v28, v29
v_cvt_pk_bf16_f32 v67, -v29, v28
v_add_f32 v24, v24, v23
v_cos_f32 v28, v24
v_sin_f32 v29, v24
s_nop 0
v_cvt_pk_bf16_f32 v52, v28, v29
v_cvt_pk_bf16_f32 v68, -v29, v28
v_add_f32 v24, v24, v23
v_cos_f32 v28, v24
v_sin_f32 v29, v24
s_nop 0
v_cvt_pk_bf16_f32 v53, v28, v29
v_cvt_pk_bf16_f32 v69, -v29, v28
v_add_f32 v24, v24, v23
v_cos_f32 v28, v24
v_sin_f32 v29, v24
s_nop 0
v_cvt_pk_bf16_f32 v54, v28, v29
v_cvt_pk_bf16_f32 v70, -v29, v28
v_add_f32 v24, v24, v23
v_cos_f32 v28, v24
v_sin_f32 v29, v24
s_nop 0
v_cvt_pk_bf16_f32 v55, v28, v29
v_cvt_pk_bf16_f32 v71, -v29, v28
v_add_f32 v23, 4.0, v237
v_mul_f32 v23, 0x3d000000, v23
v_mul_f32 v24, v23, v239
v_cos_f32 v28, v24
v_sin_f32 v29, v24
s_nop 0
v_cvt_pk_bf16_f32 v56, v28, v29
v_cvt_pk_bf16_f32 v72, -v29, v28
v_add_f32 v24, v24, v23
v_cos_f32 v28, v24
v_sin_f32 v29, v24
s_nop 0
v_cvt_pk_bf16_f32 v57, v28, v29
v_cvt_pk_bf16_f32 v73, -v29, v28
v_add_f32 v24, v24, v23
v_cos_f32 v28, v24
v_sin_f32 v29, v24
s_nop 0
v_cvt_pk_bf16_f32 v58, v28, v29
v_cvt_pk_bf16_f32 v74, -v29, v28
v_add_f32 v24, v24, v23
v_cos_f32 v28, v24
v_sin_f32 v29, v24
s_nop 0
v_cvt_pk_bf16_f32 v59, v28, v29
v_cvt_pk_bf16_f32 v75, -v29, v28
v_add_f32 v24, v24, v23
v_cos_f32 v28, v24
v_sin_f32 v29, v24
s_nop 0
v_cvt_pk_bf16_f32 v60, v28, v29
v_cvt_pk_bf16_f32 v76, -v29, v28
v_add_f32 v24, v24, v23
v_cos_f32 v28, v24
v_sin_f32 v29, v24
s_nop 0
v_cvt_pk_bf16_f32 v61, v28, v29
v_cvt_pk_bf16_f32 v77, -v29, v28
v_add_f32 v24, v24, v23
v_cos_f32 v28, v24
v_sin_f32 v29, v24
s_nop 0
v_cvt_pk_bf16_f32 v62, v28, v29
v_cvt_pk_bf16_f32 v78, -v29, v28
v_add_f32 v24, v24, v23
v_cos_f32 v28, v24
v_sin_f32 v29, v24
s_nop 0
v_cvt_pk_bf16_f32 v63, v28, v29
v_cvt_pk_bf16_f32 v79, -v29, v28
s_lshl_b32 s56, s40, 4
v_cvt_f32_u32 v24, s56
v_add_f32 v26, v24, v240
v_mul_f32 v23, 0x3a000000, v237
v_mul_f32 v24, v23, v26
v_cos_f32 v112, v24
v_sin_f32 v120, v24
v_add_f32 v24, v24, v23
v_cos_f32 v113, v24
v_sin_f32 v121, v24
v_add_f32 v24, v24, v23
v_cos_f32 v114, v24
v_sin_f32 v122, v24
v_add_f32 v24, v24, v23
v_cos_f32 v115, v24
v_sin_f32 v123, v24
v_add_f32 v23, 4.0, v237
v_mul_f32 v23, 0x3a000000, v23
v_mul_f32 v24, v23, v26
v_cos_f32 v116, v24
v_sin_f32 v124, v24
v_add_f32 v24, v24, v23
v_cos_f32 v117, v24
v_sin_f32 v125, v24
v_add_f32 v24, v24, v23
v_cos_f32 v118, v24
v_sin_f32 v126, v24
v_add_f32 v24, v24, v23
v_cos_f32 v119, v24
v_sin_f32 v127, v24
v_mul_f32 v23, 0x3c800000, v238
v_mul_f32 v24, v240, v23
v_mul_f32 v26, 0x41400000, v23
v_cos_f32 v28, v24
v_sin_f32 v29, v24
s_nop 0
v_cvt_pk_bf16_f32 v80, v28, v29
v_cvt_pk_bf16_f32 v96, -v29, v28
v_add_f32 v24, v24, v23
v_cos_f32 v28, v24
v_sin_f32 v29, v24
s_nop 0
v_cvt_pk_bf16_f32 v81, v28, v29
v_cvt_pk_bf16_f32 v97, -v29, v28
v_add_f32 v24, v24, v23
v_cos_f32 v28, v24
v_sin_f32 v29, v24
s_nop 0
v_cvt_pk_bf16_f32 v82, v28, v29
v_cvt_pk_bf16_f32 v98, -v29, v28
v_add_f32 v24, v24, v23
v_cos_f32 v28, v24
v_sin_f32 v29, v24
s_nop 0
v_cvt_pk_bf16_f32 v83, v28, v29
v_cvt_pk_bf16_f32 v99, -v29, v28
v_add_f32 v24, v24, v23
v_add_f32 v24, v24, v26
v_cos_f32 v28, v24
v_sin_f32 v29, v24
s_nop 0
v_cvt_pk_bf16_f32 v84, v28, v29
v_cvt_pk_bf16_f32 v100, -v29, v28
v_add_f32 v24, v24, v23
v_cos_f32 v28, v24
v_sin_f32 v29, v24
s_nop 0
v_cvt_pk_bf16_f32 v85, v28, v29
v_cvt_pk_bf16_f32 v101, -v29, v28
v_add_f32 v24, v24, v23
v_cos_f32 v28, v24
v_sin_f32 v29, v24
s_nop 0
v_cvt_pk_bf16_f32 v86, v28, v29
v_cvt_pk_bf16_f32 v102, -v29, v28
v_add_f32 v24, v24, v23
v_cos_f32 v28, v24
v_sin_f32 v29, v24
s_nop 0
v_cvt_pk_bf16_f32 v87, v28, v29
v_cvt_pk_bf16_f32 v103, -v29, v28
v_add_f32 v24, v24, v23
v_add_f32 v24, v24, v26
v_cos_f32 v28, v24
v_sin_f32 v29, v24
s_nop 0
v_cvt_pk_bf16_f32 v88, v28, v29
v_cvt_pk_bf16_f32 v104, -v29, v28
v_add_f32 v24, v24, v23
v_cos_f32 v28, v24
v_sin_f32 v29, v24
s_nop 0
v_cvt_pk_bf16_f32 v89, v28, v29
v_cvt_pk_bf16_f32 v105, -v29, v28
v_add_f32 v24, v24, v23
v_cos_f32 v28, v24
v_sin_f32 v29, v24
s_nop 0
v_cvt_pk_bf16_f32 v90, v28, v29
v_cvt_pk_bf16_f32 v106, -v29, v28
v_add_f32 v24, v24, v23
v_cos_f32 v28, v24
v_sin_f32 v29, v24
s_nop 0
v_cvt_pk_bf16_f32 v91, v28, v29
v_cvt_pk_bf16_f32 v107, -v29, v28
v_add_f32 v24, v24, v23
v_add_f32 v24, v24, v26
v_cos_f32 v28, v24
v_sin_f32 v29, v24
s_nop 0
v_cvt_pk_bf16_f32 v92, v28, v29
v_cvt_pk_bf16_f32 v108, -v29, v28
v_add_f32 v24, v24, v23
v_cos_f32 v28, v24
v_sin_f32 v29, v24
s_nop 0
v_cvt_pk_bf16_f32 v93, v28, v29
v_cvt_pk_bf16_f32 v109, -v29, v28
v_add_f32 v24, v24, v23
v_cos_f32 v28, v24
v_sin_f32 v29, v24
s_nop 0
v_cvt_pk_bf16_f32 v94, v28, v29
v_cvt_pk_bf16_f32 v110, -v29, v28
v_add_f32 v24, v24, v23
v_cos_f32 v28, v24
v_sin_f32 v29, v24
s_nop 0
v_cvt_pk_bf16_f32 v95, v28, v29
v_cvt_pk_bf16_f32 v111, -v29, v28
v_add_f32 v24, v24, v23
v_mul_f32 v23, 0x3a000000, v238
v_mul_f32 v24, v23, v239
v_cos_f32 v128, v24
v_sin_f32 v136, v24
v_add_f32 v24, v24, v23
v_cos_f32 v129, v24
v_sin_f32 v137, v24
v_add_f32 v24, v24, v23
v_cos_f32 v130, v24
v_sin_f32 v138, v24
v_add_f32 v24, v24, v23
v_cos_f32 v131, v24
v_sin_f32 v139, v24
v_add_f32 v24, v24, v23
v_cos_f32 v132, v24
v_sin_f32 v140, v24
v_add_f32 v24, v24, v23
v_cos_f32 v133, v24
v_sin_f32 v141, v24
v_add_f32 v24, v24, v23
v_cos_f32 v134, v24
v_sin_f32 v142, v24
v_add_f32 v24, v24, v23
v_cos_f32 v135, v24
v_sin_f32 v143, v24
v_mul_f32 v128, 0x36000000, v128
v_mul_f32 v129, 0x36000000, v129
v_mul_f32 v130, 0x36000000, v130
v_mul_f32 v131, 0x36000000, v131
v_mul_f32 v132, 0x36000000, v132
v_mul_f32 v133, 0x36000000, v133
v_mul_f32 v134, 0x36000000, v134
v_mul_f32 v135, 0x36000000, v135
v_mul_f32 v136, 0x36000000, v136
v_mul_f32 v137, 0x36000000, v137
v_mul_f32 v138, 0x36000000, v138
v_mul_f32 v139, 0x36000000, v139
v_mul_f32 v140, 0x36000000, v140
v_mul_f32 v141, 0x36000000, v141
v_mul_f32 v142, 0x36000000, v142
v_mul_f32 v143, 0x36000000, v143
s_and_b32 s56, s2, 7
s_lshr_b32 s57, s2, 3
s_lshl_b32 s85, s56, 2
s_and_b32 s58, s57, 3
s_add_u32 s85, s85, s58
s_lshr_b32 s101, s57, 2
s_mov_b32 s8, s78
s_and_b32 s9, s79, 0xffff
s_mov_b32 s10, 1409024
s_mov_b32 s11, 0x20000
s_mov_b32 s12, s90
s_and_b32 s13, s91, 0xffff
s_mov_b32 s14, 5636096
s_mov_b32 s15, 0x20000
s_add_u32 s16, s90, 8388608
s_addc_u32 s17, s91, 0
s_and_b32 s17, s17, 0xffff
s_mov_b32 s18, 2097152
s_mov_b32 s19, 0x20000
s_add_u32 s68, s90, 6291456
s_addc_u32 s69, s91, 0
s_and_b32 s69, s69, 0xffff
s_mov_b32 s70, 2097152
s_mov_b32 s71, 0x20000
v_lshrrev_b32 v22, 3, v1
v_and_b32 v23, 7, v1
v_bfe_u32 v24, v1, 4, 1
v_lshlrev_b32 v24, 2, v24
v_xor_b32 v23, v23, v24
v_lshlrev_b32 v23, 4, v23
v_lshl_add_u32 v224, v22, 10, v23
v_lshlrev_b32 v226, 4, v1
s_lshl_b32 s47, s40, 14
s_lshl_b32 s56, s101, 7
s_add_u32 s47, s47, s56
s_mul_i32 s48, s85, 172
s_add_u32 s48, s48, s40
s_lshl_b32 s48, s48, 10
s_add_u32 s49, s48, 88064
s_lshl_b32 s50, s40, 12
v_lshrrev_b32 v22, 3, v1
v_and_b32 v23, 1023, v224
v_lshl_add_u32 v225, v22, 12, v23
v_lshlrev_b32 v241, 7, v14
v_lshl_add_u32 v241, v13, 5, v241
v_lshlrev_b32 v242, 4, v14
v_lshl_add_u32 v242, v13, 9, v242
v_lshlrev_b32 v235, 4, v1
v_add_u32 v235, 114688, v235
s_lshl_b32 s56, s40, 11
v_add_u32 v234, s56, v235
v_lshlrev_b32 v236, 6, v14
v_lshl_add_u32 v236, v13, 4, v236
s_lshl_b32 s56, s40, 10
v_add_u32 v236, s56, v236
v_and_b32 v20, 15, v1
s_lshr_b32 s56, s2, 4
v_lshlrev_b32 v21, 4, v20
v_add_u32 v21, s56, v21
s_lshr_b32 s56, s85, 1
s_lshl_b32 s56, s56, 4
v_add_u32 v20, s56, v20
v_cmp_gt_u32 vcc, 16, v1
s_nop 1
v_cndmask_b32 v20, v20, v21, vcc
s_lshr_b32 s56, s2, 5
v_and_b32 v21, 31, v1
v_lshlrev_b32 v21, 3, v21
v_add_u32 v21, s56, v21
v_and_b32 v22, 1, v21
v_lshlrev_b32 v22, 3, v22
v_bfe_u32 v23, v21, 3, 3
v_add_u32 v22, v22, v23
v_bfe_u32 v23, v21, 1, 2
v_lshlrev_b32 v23, 2, v23
v_lshrrev_b32 v21, 6, v21
v_add_u32 v23, v23, v21
v_lshl_add_u32 v22, v22, 4, v23
v_cmp_gt_u32 vcc, 32, v1
s_nop 1
v_cndmask_b32 v20, v22, v20, vcc
v_lshlrev_b32 v228, 7, v20
v_add_u32 v228, 884736, v228
s_waitcnt vmcnt(0) lgkmcnt(0)
s_mov_b32 s24, s72
s_and_b32 s25, s73, 0xffff
s_mov_b32 s26, 2097152
s_mov_b32 s27, 0x20000
s_mov_b32 s28, s80
s_and_b32 s29, s81, 0xffff
s_mov_b32 s30, 2097152
s_mov_b32 s31, 0x20000
s_barrier
s_lshl_b32 s98, s84, 7
s_add_u32 s98, s98, 884736
s_cmp_eq_u32 s40, 0
s_cselect_b32 s98, s98, 2147418112
v_mov_b32 v24, s66
s_mov_b64 exec, 1
buffer_store_dword v24, v11, s[20:23], s98 offen sc1
s_mov_b64 exec, -1
s_cmp_eq_u32 s40, 0
s_cbranch_scc0 L_p2_done
s_mov_b32 s100, 0
s_cmp_eq_u32 s2, 0
s_cbranch_scc1 L_p2all
L_p2:
buffer_load_dword v230, v228, s[20:23], 0 offen sc1
s_waitcnt vmcnt(0)
v_cmp_ne_u32 vcc, s66, v230
s_nop 3
s_cmp_eq_u64 vcc, 0
s_cbranch_scc1 L_p2_done
s_add_u32 s100, s100, 1
s_cmp_lt_u32 s100, 50000
s_cbranch_scc1 L_p2
L_p2_done:
s_barrier
s_lshl_b32 s57, s40, 11
s_lshl_b32 s59, s2, 13
s_add_u32 s59, s59, s57
buffer_load_dwordx4 v[32:35], v241, s[68:71], s59 offen offset:0 sc1
buffer_load_dwordx4 v[36:39], v241, s[68:71], s59 offen offset:16 sc1
s_cmp_eq_u32 s2, 0
s_cselect_b32 s58, 2105344, 0
s_add_u32 s58, s58, s59
buffer_load_dwordx4 v[40:43], v242, s[32:35], s58 offen offset:0 sc1
buffer_load_dwordx4 v[44:47], v242, s[32:35], s58 offen offset:256 sc1
s_add_u32 s58, s57, 2097152
s_cmp_eq_u32 s2, 0
s_cselect_b32 s58, s58, 2147418112
buffer_load_dwordx4 v[216:219], v242, s[32:35], s58 offen offset:0 sc1
buffer_load_dwordx4 v[220:223], v242, s[32:35], s58 offen offset:256 sc1
s_waitcnt lgkmcnt(0)
s_barrier
s_waitcnt lgkmcnt(0)
s_barrier
s_waitcnt lgkmcnt(0)
s_barrier
s_waitcnt vmcnt(4)
v_mfma_f32_16x16x32_bf16 v[144:147], v[32:35], v[48:51], 0
v_mfma_f32_16x16x32_bf16 v[148:151], v[32:35], v[56:59], 0
v_mfma_f32_16x16x32_bf16 v[152:155], v[32:35], v[64:67], 0
v_mfma_f32_16x16x32_bf16 v[156:159], v[32:35], v[72:75], 0
v_mfma_f32_16x16x32_bf16 v[144:147], v[36:39], v[52:55], v[144:147]
v_mfma_f32_16x16x32_bf16 v[148:151], v[36:39], v[60:63], v[148:151]
v_mfma_f32_16x16x32_bf16 v[152:155], v[36:39], v[68:71], v[152:155]
v_mfma_f32_16x16x32_bf16 v[156:159], v[36:39], v[76:79], v[156:159]
s_nop 4
v_mul_f32 v28, v144, v112
s_nop 0
v_mul_f32 v29, v152, v112
v_fma_f32 v28, v152, v120, v28
v_fma_f32 v29, -v144, v120, v29
v_cvt_pk_bf16_f32 v160, v28, v29
v_mul_f32 v30, v145, v113
v_mul_f32 v31, v153, v113
v_fma_f32 v30, v153, v121, v30
v_fma_f32 v31, -v145, v121, v31
v_cvt_pk_bf16_f32 v161, v30, v31
v_mul_f32 v28, v146, v114
v_mul_f32 v29, v154, v114
v_fma_f32 v28, v154, v122, v28
v_fma_f32 v29, -v146, v122, v29
v_cvt_pk_bf16_f32 v162, v28, v29
v_mul_f32 v30, v147, v115
v_mul_f32 v31, v155, v115
v_fma_f32 v30, v155, v123, v30
v_fma_f32 v31, -v147, v123, v31
v_cvt_pk_bf16_f32 v163, v30, v31
v_mul_f32 v28, v148, v116
v_mul_f32 v29, v156, v116
v_fma_f32 v28, v156, v124, v28
v_fma_f32 v29, -v148, v124, v29
v_cvt_pk_bf16_f32 v164, v28, v29
v_mul_f32 v30, v149, v117
v_mul_f32 v31, v157, v117
v_fma_f32 v30, v157, v125, v30
v_fma_f32 v31, -v149, v125, v31
v_cvt_pk_bf16_f32 v165, v30, v31
v_mul_f32 v28, v150, v118
v_mul_f32 v29, v158, v118
v_fma_f32 v28, v158, v126, v28
v_fma_f32 v29, -v150, v126, v29
v_cvt_pk_bf16_f32 v166, v28, v29
v_mul_f32 v30, v151, v119
v_mul_f32 v31, v159, v119
v_fma_f32 v30, v159, v127, v30
v_fma_f32 v31, -v151, v127, v31
v_cvt_pk_bf16_f32 v167, v30, v31
ds_write_b128 v234, v[160:163] offset:0
ds_write_b128 v234, v[164:167] offset:1024
s_waitcnt lgkmcnt(0)
s_barrier
ds_read_b128 v[168:171], v235 offset:0
ds_read_b128 v[172:175], v235 offset:1024
ds_read_b128 v[176:179], v235 offset:2048
ds_read_b128 v[180:183], v235 offset:3072
ds_read_b128 v[184:187], v235 offset:4096
ds_read_b128 v[188:191], v235 offset:5120
ds_read_b128 v[192:195], v235 offset:6144
ds_read_b128 v[196:199], v235 offset:7168
s_waitcnt vmcnt(0)
v_lshlrev_b32 v200, 16, v40
v_and_b32 v208, s37, v40
v_lshlrev_b32 v201, 16, v41
v_and_b32 v209, s37, v41
v_lshlrev_b32 v202, 16, v42
v_and_b32 v210, s37, v42
v_lshlrev_b32 v203, 16, v43
v_and_b32 v211, s37, v43
v_lshlrev_b32 v204, 16, v44
v_and_b32 v212, s37, v44
v_lshlrev_b32 v205, 16, v45
v_and_b32 v213, s37, v45
v_lshlrev_b32 v206, 16, v46
v_and_b32 v214, s37, v46
v_lshlrev_b32 v207, 16, v47
v_and_b32 v215, s37, v47
s_waitcnt lgkmcnt(6)
v_mfma_f32_16x16x32_bf16 v[144:147], v[80:83], v[168:171], 0
v_mfma_f32_16x16x32_bf16 v[148:151], v[80:83], v[172:175], 0
v_mfma_f32_16x16x32_bf16 v[152:155], v[96:99], v[168:171], 0
v_mfma_f32_16x16x32_bf16 v[156:159], v[96:99], v[172:175], 0
s_waitcnt lgkmcnt(4)
v_mfma_f32_16x16x32_bf16 v[144:147], v[84:87], v[176:179], v[144:147]
v_mfma_f32_16x16x32_bf16 v[148:151], v[84:87], v[180:183], v[148:151]
v_mfma_f32_16x16x32_bf16 v[152:155], v[100:103], v[176:179], v[152:155]
v_mfma_f32_16x16x32_bf16 v[156:159], v[100:103], v[180:183], v[156:159]
s_waitcnt lgkmcnt(2)
v_mfma_f32_16x16x32_bf16 v[144:147], v[88:91], v[184:187], v[144:147]
v_mfma_f32_16x16x32_bf16 v[148:151], v[88:91], v[188:191], v[148:151]
v_mfma_f32_16x16x32_bf16 v[152:155], v[104:107], v[184:187], v[152:155]
v_mfma_f32_16x16x32_bf16 v[156:159], v[104:107], v[188:191], v[156:159]
s_waitcnt lgkmcnt(0)
v_mfma_f32_16x16x32_bf16 v[144:147], v[92:95], v[192:195], v[144:147]
v_mfma_f32_16x16x32_bf16 v[148:151], v[92:95], v[196:199], v[148:151]
v_mfma_f32_16x16x32_bf16 v[152:155], v[108:111], v[192:195], v[152:155]
v_mfma_f32_16x16x32_bf16 v[156:159], v[108:111], v[196:199], v[156:159]
s_cmp_eq_u32 s2, 0
s_cbranch_scc1 L_sp1
L_sp1_ret:
s_waitcnt lgkmcnt(0)
s_barrier
s_cmp_eq_u32 s2, 0
s_cbranch_scc1 L_sp2
v_mul_f32 v28, v144, v200
v_mul_f32 v29, -v144, v208
v_fma_f32 v28, -v152, v208, v28
v_fma_f32 v29, -v152, v200, v29
v_cvt_pk_bf16_f32 v160, v28, v29
v_mul_f32 v30, v145, v201
v_mul_f32 v31, -v145, v209
v_fma_f32 v30, -v153, v209, v30
v_fma_f32 v31, -v153, v201, v31
v_cvt_pk_bf16_f32 v161, v30, v31
v_mul_f32 v28, v146, v202
v_mul_f32 v29, -v146, v210
v_fma_f32 v28, -v154, v210, v28
v_fma_f32 v29, -v154, v202, v29
v_cvt_pk_bf16_f32 v162, v28, v29
v_mul_f32 v30, v147, v203
v_mul_f32 v31, -v147, v211
v_fma_f32 v30, -v155, v211, v30
v_fma_f32 v31, -v155, v203, v31
v_cvt_pk_bf16_f32 v163, v30, v31
v_mul_f32 v28, v148, v204
v_mul_f32 v29, -v148, v212
v_fma_f32 v28, -v156, v212, v28
v_fma_f32 v29, -v156, v204, v29
v_cvt_pk_bf16_f32 v164, v28, v29
v_mul_f32 v30, v149, v205
v_mul_f32 v31, -v149, v213
v_fma_f32 v30, -v157, v213, v30
v_fma_f32 v31, -v157, v205, v31
v_cvt_pk_bf16_f32 v165, v30, v31
v_mul_f32 v28, v150, v206
v_mul_f32 v29, -v150, v214
v_fma_f32 v28, -v158, v214, v28
v_fma_f32 v29, -v158, v206, v29
v_cvt_pk_bf16_f32 v166, v28, v29
v_mul_f32 v30, v151, v207
v_mul_f32 v31, -v151, v215
v_fma_f32 v30, -v159, v215, v30
v_fma_f32 v31, -v159, v207, v31
v_cvt_pk_bf16_f32 v167, v30, v31
L_sp2_ret:
ds_write_b128 v234, v[160:163] offset:8192
ds_write_b128 v234, v[164:167] offset:9216
s_waitcnt lgkmcnt(0)
s_barrier
ds_read_b128 v[168:171], v235 offset:8192
ds_read_b128 v[172:175], v235 offset:9216
ds_read_b128 v[176:179], v235 offset:10240
ds_read_b128 v[180:183], v235 offset:11264
ds_read_b128 v[184:187], v235 offset:12288
ds_read_b128 v[188:191], v235 offset:13312
ds_read_b128 v[192:195], v235 offset:14336
ds_read_b128 v[196:199], v235 offset:15360
s_waitcnt lgkmcnt(6)
v_mfma_f32_16x16x32_bf16 v[144:147], v[168:171], v[80:83], 0
v_mfma_f32_16x16x32_bf16 v[148:151], v[172:175], v[80:83], 0
v_mfma_f32_16x16x32_bf16 v[152:155], v[168:171], v[96:99], 0
v_mfma_f32_16x16x32_bf16 v[156:159], v[172:175], v[96:99], 0
s_waitcnt lgkmcnt(4)
v_mfma_f32_16x16x32_bf16 v[144:147], v[176:179], v[84:87], v[144:147]
v_mfma_f32_16x16x32_bf16 v[148:151], v[180:183], v[84:87], v[148:151]
v_mfma_f32_16x16x32_bf16 v[152:155], v[176:179], v[100:103], v[152:155]
v_mfma_f32_16x16x32_bf16 v[156:159], v[180:183], v[100:103], v[156:159]
s_waitcnt lgkmcnt(2)
v_mfma_f32_16x16x32_bf16 v[144:147], v[184:187], v[88:91], v[144:147]
v_mfma_f32_16x16x32_bf16 v[148:151], v[188:191], v[88:91], v[148:151]
v_mfma_f32_16x16x32_bf16 v[152:155], v[184:187], v[104:107], v[152:155]
v_mfma_f32_16x16x32_bf16 v[156:159], v[188:191], v[104:107], v[156:159]
s_waitcnt lgkmcnt(0)
v_mfma_f32_16x16x32_bf16 v[144:147], v[192:195], v[92:95], v[144:147]
v_mfma_f32_16x16x32_bf16 v[148:151], v[196:199], v[92:95], v[148:151]
v_mfma_f32_16x16x32_bf16 v[152:155], v[192:195], v[108:111], v[152:155]
v_mfma_f32_16x16x32_bf16 v[156:159], v[196:199], v[108:111], v[156:159]
s_nop 4
v_mul_f32 v28, v144, v128
s_nop 0
v_mul_f32 v29, v152, v128
v_fma_f32 v28, v152, v136, v28
v_fma_f32 v29, -v144, v136, v29
v_cvt_pk_bf16_f32 v160, v28, v29
v_mul_f32 v30, v145, v129
v_mul_f32 v31, v153, v129
v_fma_f32 v30, v153, v137, v30
v_fma_f32 v31, -v145, v137, v31
v_cvt_pk_bf16_f32 v161, v30, v31
v_mul_f32 v28, v146, v130
v_mul_f32 v29, v154, v130
v_fma_f32 v28, v154, v138, v28
v_fma_f32 v29, -v146, v138, v29
v_cvt_pk_bf16_f32 v162, v28, v29
v_mul_f32 v30, v147, v131
v_mul_f32 v31, v155, v131
v_fma_f32 v30, v155, v139, v30
v_fma_f32 v31, -v147, v139, v31
v_cvt_pk_bf16_f32 v163, v30, v31
s_waitcnt lgkmcnt(0)
s_barrier
v_mul_f32 v28, v148, v132
v_mul_f32 v29, v156, v132
v_fma_f32 v28, v156, v140, v28
v_fma_f32 v29, -v148, v140, v29
v_cvt_pk_bf16_f32 v164, v28, v29
v_mul_f32 v30, v149, v133
v_mul_f32 v31, v157, v133
v_fma_f32 v30, v157, v141, v30
v_fma_f32 v31, -v149, v141, v31
v_cvt_pk_bf16_f32 v165, v30, v31
v_mul_f32 v28, v150, v134
v_mul_f32 v29, v158, v134
v_fma_f32 v28, v158, v142, v28
v_fma_f32 v29, -v150, v142, v29
v_cvt_pk_bf16_f32 v166, v28, v29
v_mul_f32 v30, v151, v135
v_mul_f32 v31, v159, v135
v_fma_f32 v30, v159, v143, v30
v_fma_f32 v31, -v151, v143, v31
v_cvt_pk_bf16_f32 v167, v30, v31
v_mfma_f32_16x16x32_bf16 v[144:147], v[48:51], v[160:163], 0
v_mfma_f32_16x16x32_bf16 v[148:151], v[56:59], v[160:163], 0
v_mfma_f32_16x16x32_bf16 v[152:155], v[64:67], v[160:163], 0
v_mfma_f32_16x16x32_bf16 v[156:159], v[72:75], v[160:163], 0
v_mfma_f32_16x16x32_bf16 v[144:147], v[52:55], v[164:167], v[144:147]
v_mfma_f32_16x16x32_bf16 v[148:151], v[60:63], v[164:167], v[148:151]
v_mfma_f32_16x16x32_bf16 v[152:155], v[68:71], v[164:167], v[152:155]
v_mfma_f32_16x16x32_bf16 v[156:159], v[76:79], v[164:167], v[156:159]
s_lshl_b32 s58, s2, 13
s_add_u32 s59, s58, 4096
s_nop 2
v_cvt_pk_bf16_f32 v168, v144, v145
v_cvt_pk_bf16_f32 v169, v146, v147
v_cvt_pk_bf16_f32 v170, v148, v149
v_cvt_pk_bf16_f32 v171, v150, v151
buffer_store_dwordx4 v[168:171], v236, s[16:19], s58 offen sc1
v_cvt_pk_bf16_f32 v176, v152, v153
v_cvt_pk_bf16_f32 v177, v154, v155
v_cvt_pk_bf16_f32 v178, v156, v157
v_cvt_pk_bf16_f32 v179, v158, v159
buffer_store_dwordx4 v[176:179], v236, s[16:19], s59 offen sc1
s_lshl_b32 s60, s40, 16
s_lshl_b32 s56, s85, 7
s_add_u32 s60, s60, s56
s_mov_b32 s38, 2147418112
s_waitcnt lgkmcnt(0)
s_barrier
s_waitcnt lgkmcnt(0)
s_barrier
s_waitcnt lgkmcnt(0)
s_barrier
s_waitcnt vmcnt(0)
s_waitcnt lgkmcnt(0)
s_barrier
s_lshr_b32 s98, s2, 4
s_lshl_b32 s98, s98, 7
s_add_u32 s98, s98, 868352
s_cmp_eq_u32 s40, 0
s_cselect_b32 s98, s98, 2147418112
v_mov_b32 v24, 1
s_mov_b64 exec, 1
buffer_atomic_add v24, v11, s[20:23], s98 offen sc1
s_mov_b64 exec, -1
s_waitcnt lgkmcnt(0)
s_barrier
s_waitcnt lgkmcnt(0)
s_barrier
s_waitcnt lgkmcnt(0)
s_barrier
s_waitcnt lgkmcnt(0)
s_barrier
s_waitcnt lgkmcnt(0)
s_barrier
s_waitcnt lgkmcnt(0)
s_barrier
s_waitcnt lgkmcnt(0)
s_barrier
v_and_b32 v228, 15, v1
v_lshlrev_b32 v228, 7, v228
s_cmp_eq_u32 s40, 0
s_cselect_b32 s62, 868352, s38
s_lshl_b32 s63, s66, 5
s_add_u32 s63, s63, 16
s_mov_b64 exec, 0xffff
buffer_load_dword v230, v228, s[20:23], s62 offen sc1
s_mov_b64 exec, -1
s_waitcnt lgkmcnt(0)
s_barrier
s_cmp_eq_u32 s40, 0
s_cbranch_scc0 L_spin3_ret
s_waitcnt vmcnt(0)
s_mov_b64 exec, 0xffff
v_cmp_ne_u32 vcc, s63, v230
s_mov_b64 exec, -1
s_nop 2
s_cmp_lg_u64 vcc, 0
s_cbranch_scc1 L_spin3
L_spin3_ret:
s_waitcnt lgkmcnt(0)
s_barrier
s_add_u32 s51, s60, 0
s_add_u32 m0, s50, 16384
s_nop 0
buffer_load_dwordx4 v225, s[16:19], s51 offen sc1 lds
s_add_u32 s51, s51, 32768
s_addk_i32 m0, 1024
s_nop 0
buffer_load_dwordx4 v225, s[16:19], s51 offen sc1 lds
s_add_u32 s51, s60, 262144
s_add_u32 m0, s50, 32768
s_nop 0
buffer_load_dwordx4 v225, s[16:19], s51 offen sc1 lds
s_add_u32 s51, s51, 32768
s_addk_i32 m0, 1024
s_nop 0
buffer_load_dwordx4 v225, s[16:19], s51 offen sc1 lds
s_add_u32 s51, s60, 524288
s_add_u32 m0, s50, 49152
s_nop 0
buffer_load_dwordx4 v225, s[16:19], s51 offen sc1 lds
s_add_u32 s51, s51, 32768
s_addk_i32 m0, 1024
s_nop 0
buffer_load_dwordx4 v225, s[16:19], s51 offen sc1 lds
s_waitcnt lgkmcnt(0)
s_barrier
s_add_u32 s51, s60, 786432
s_add_u32 m0, s50, 65536
s_nop 0
buffer_load_dwordx4 v225, s[16:19], s51 offen sc1 lds
s_add_u32 s51, s51, 32768
s_addk_i32 m0, 1024
s_nop 0
buffer_load_dwordx4 v225, s[16:19], s51 offen sc1 lds
s_waitcnt lgkmcnt(0)
s_barrier
s_add_u32 s51, s60, 1048576
s_add_u32 m0, s50, 81920
s_nop 0
buffer_load_dwordx4 v225, s[16:19], s51 offen sc1 lds
v_lshrrev_b32 v2, 3, v1
s_lshl_b32 s56, s39, 3
v_add_u32 v2, s56, v2
v_and_b32 v3, 31, v2
v_lshrrev_b32 v4, 5, v2
v_lshlrev_b32 v3, 16, v3
v_lshl_add_u32 v3, v4, 10, v3
v_and_b32 v4, 7, v1
s_add_u32 s51, s51, 32768
s_addk_i32 m0, 1024
s_nop 0
buffer_load_dwordx4 v225, s[16:19], s51 offen sc1 lds
v_lshl_add_u32 v3, v4, 4, v3
s_lshl_b32 s56, s85, 11
s_lshl_b32 s57, s101, 7
s_add_u32 s56, s56, s57
v_add_u32 v12, s56, v3
v_mul_u32_u24 v13, 272, v2
v_lshl_add_u32 v13, v4, 5, v13
buffer_load_dwordx4 v[16:19], v12, s[24:27], 0 offen
s_waitcnt vmcnt(9)
s_waitcnt lgkmcnt(0)
s_barrier
s_add_u32 s51, s60, 1310720
s_add_u32 m0, s50, 98304
s_nop 0
buffer_load_dwordx4 v225, s[16:19], s51 offen sc1 lds
s_add_u32 s51, s51, 32768
s_addk_i32 m0, 1024
s_nop 0
buffer_load_dwordx4 v225, s[16:19], s51 offen sc1 lds
s_waitcnt vmcnt(9)
s_waitcnt lgkmcnt(0)
s_barrier
s_add_u32 s51, s60, 1572864
s_add_u32 m0, s50, 0
s_nop 0
buffer_load_dwordx4 v225, s[16:19], s51 offen sc1 lds
s_add_u32 s51, s51, 32768
s_addk_i32 m0, 1024
s_nop 0
buffer_load_dwordx4 v225, s[16:19], s51 offen sc1 lds
s_waitcnt vmcnt(9)
s_waitcnt lgkmcnt(0)
s_barrier
s_add_u32 s51, s60, 1835008
s_add_u32 m0, s50, 16384
s_nop 0
buffer_load_dwordx4 v225, s[16:19], s51 offen sc1 lds
s_add_u32 s51, s51, 32768
s_addk_i32 m0, 1024
s_nop 0
buffer_load_dwordx4 v225, s[16:19], s51 offen sc1 lds
s_waitcnt vmcnt(9)
s_waitcnt lgkmcnt(0)
s_barrier
s_waitcnt vmcnt(7)
s_waitcnt lgkmcnt(0)
s_barrier
s_waitcnt vmcnt(4)
s_waitcnt lgkmcnt(0)
s_barrier
s_waitcnt vmcnt(2)
s_waitcnt lgkmcnt(0)
s_barrier
s_waitcnt vmcnt(0)
s_waitcnt lgkmcnt(0)
s_barrier
s_barrier
s_barrier
ds_read_b128 v[24:27], v13
ds_read_b128 v[28:31], v13 offset:16
s_waitcnt vmcnt(0) lgkmcnt(0)
v_lshlrev_b32 v2, 16, v16
v_and_b32 v3, 0xffff0000, v16
v_add_f32 v2, v2, v24
v_add_f32 v3, v3, v25
v_cvt_pk_bf16_f32 v16, v2, v3
v_lshlrev_b32 v2, 16, v17
v_and_b32 v3, 0xffff0000, v17
v_add_f32 v2, v2, v26
v_add_f32 v3, v3, v27
v_cvt_pk_bf16_f32 v17, v2, v3
v_lshlrev_b32 v2, 16, v18
v_and_b32 v3, 0xffff0000, v18
v_add_f32 v2, v2, v28
v_add_f32 v3, v3, v29
v_cvt_pk_bf16_f32 v18, v2, v3
v_lshlrev_b32 v2, 16, v19
v_and_b32 v3, 0xffff0000, v19
v_add_f32 v2, v2, v30
v_add_f32 v3, v3, v31
v_cvt_pk_bf16_f32 v19, v2, v3
buffer_store_dwordx4 v[16:19], v12, s[28:31], 0 offen
s_endpgm
L_ng:
s_mov_b32 s100, 0
L_ng_a:
buffer_load_dword v17, v11, s[52:55], 0 offen sc1
s_waitcnt vmcnt(0)
v_readfirstlane_b32 s66, v17
s_nop 3
s_cmp_lg_u32 s66, 0
s_cbranch_scc1 L_ng_ret
s_add_u32 s100, s100, 1
s_cmp_gt_u32 s100, 50000
s_cbranch_scc1 L_ng_ret
s_branch L_ng_a
L_p2all:
v_lshlrev_b32 v231, 7, v1
v_add_u32 v231, 884736, v231
L_p2all_a:
s_mov_b32 s56, 0
buffer_load_dword v144, v231, s[20:23], s56 offen sc1
s_mov_b32 s56, 8192
buffer_load_dword v145, v231, s[20:23], s56 offen sc1
s_mov_b32 s56, 16384
buffer_load_dword v146, v231, s[20:23], s56 offen sc1
s_mov_b32 s56, 24576
buffer_load_dword v147, v231, s[20:23], s56 offen sc1
s_waitcnt vmcnt(0)
v_cmp_ne_u32 vcc, s66, v144
v_cmp_ne_u32 s[56:57], s66, v145
s_nop 3
s_or_b64 vcc, vcc, s[56:57]
v_cmp_ne_u32 s[56:57], s66, v146
s_nop 3
s_or_b64 vcc, vcc, s[56:57]
v_cmp_ne_u32 s[56:57], s66, v147
s_nop 3
s_or_b64 vcc, vcc, s[56:57]
s_cmp_eq_u64 vcc, 0
s_cbranch_scc1 L_p2_done
s_add_u32 s100, s100, 1
s_cmp_lt_u32 s100, 50000
s_cbranch_scc1 L_p2all_a
s_branch L_p2_done
L_spin1:
s_mov_b32 s100, 0
L_spin1_a:
buffer_load_dword v18, v19, s[20:23], 0 offen sc1
s_waitcnt vmcnt(0)
v_cmp_ne_u32 vcc, s66, v18
s_nop 3
s_cmp_eq_u64 vcc, 0
s_cbranch_scc1 L_spin1_ret
s_add_u32 s100, s100, 1
s_cmp_gt_u32 s100, 50000
s_cbranch_scc1 L_spin1_ret
s_branch L_spin1_a
L_spin3:
s_mov_b32 s100, 0
L_spin3_a:
s_mov_b64 exec, 0xffff
buffer_load_dword v230, v228, s[20:23], s62 offen sc1
s_waitcnt vmcnt(0)
v_cmp_ne_u32 vcc, s63, v230
s_mov_b64 exec, -1
s_nop 2
s_cmp_eq_u64 vcc, 0
s_cbranch_scc1 L_spin3_ret
s_add_u32 s100, s100, 1
s_cmp_gt_u32 s100, 50000
s_cbranch_scc1 L_spin3_ret
s_branch L_spin3_a
L_sp1:
v_lshlrev_b32 v23, 2, v13
s_lshl_b32 s56, s40, 4
v_add_u32 v23, s56, v23
v_add_u32 v24, 0, v229
v_mul_u32_u24 v24, 528, v24
v_lshl_add_u32 v24, v23, 3, v24
v_add_u32 v24, 131072, v24
ds_write2_b32 v24, v144, v152 offset0:0 offset1:1
ds_write2_b32 v24, v145, v153 offset0:2 offset1:3
ds_write2_b32 v24, v146, v154 offset0:4 offset1:5
ds_write2_b32 v24, v147, v155 offset0:6 offset1:7
v_add_u32 v24, 4, v229
v_mul_u32_u24 v24, 528, v24
v_lshl_add_u32 v24, v23, 3, v24
v_add_u32 v24, 131072, v24
ds_write2_b32 v24, v148, v156 offset0:0 offset1:1
ds_write2_b32 v24, v149, v157 offset0:2 offset1:3
ds_write2_b32 v24, v150, v158 offset0:4 offset1:5
ds_write2_b32 v24, v151, v159 offset0:6 offset1:7
s_cmp_eq_u32 s40, 0
s_cbranch_scc0 L_sp1_ret
v_mov_b32 v24, 131584
s_mov_b64 exec, 1
ds_write2_b32 v24, v144, v152 offset0:0 offset1:1
s_mov_b64 exec, -1
s_branch L_sp1_ret
L_sp2:
v_lshlrev_b32 v23, 2, v13
s_lshl_b32 s56, s40, 4
v_add_u32 v23, s56, v23
v_add_u32 v24, 0, v229
v_sub_u32 v25, 32, v24
v_and_b32 v25, 31, v25
v_mul_u32_u24 v25, 528, v25
v_cmp_eq_u32 vcc, 0, v24
v_mov_b32 v26, 60
s_nop 0
v_cndmask_b32 v26, v26, 61, vcc
v_sub_u32 v26, v26, v23
v_lshl_add_u32 v25, v26, 3, v25
v_add_u32 v25, 131072, v25
ds_read_b64 v[168:169], v25 offset:24
ds_read_b64 v[170:171], v25 offset:16
ds_read_b64 v[172:173], v25 offset:8
ds_read_b64 v[174:175], v25 offset:0
v_add_u32 v24, 4, v229
v_sub_u32 v25, 32, v24
v_and_b32 v25, 31, v25
v_mul_u32_u24 v25, 528, v25
v_cmp_eq_u32 vcc, 0, v24
v_mov_b32 v26, 60
s_nop 0
v_cndmask_b32 v26, v26, 61, vcc
v_sub_u32 v26, v26, v23
v_lshl_add_u32 v25, v26, 3, v25
v_add_u32 v25, 131072, v25
ds_read_b64 v[176:177], v25 offset:24
ds_read_b64 v[178:179], v25 offset:16
ds_read_b64 v[180:181], v25 offset:8
ds_read_b64 v[182:183], v25 offset:0
s_waitcnt lgkmcnt(0)
v_lshlrev_b32 v26, 16, v216
v_and_b32 v27, s37, v216
v_mul_f32 v28, v144, v200
v_fma_f32 v28, -v152, v208, v28
v_fma_f32 v28, v168, v26, v28
v_fma_f32 v28, v169, v27, v28
v_mul_f32 v29, -v144, v208
v_fma_f32 v29, -v152, v200, v29
v_fma_f32 v29, -v168, v27, v29
v_fma_f32 v29, v169, v26, v29
v_cvt_pk_bf16_f32 v160, v28, v29
v_lshlrev_b32 v26, 16, v217
v_and_b32 v27, s37, v217
v_mul_f32 v28, v145, v201
v_fma_f32 v28, -v153, v209, v28
v_fma_f32 v28, v170, v26, v28
v_fma_f32 v28, v171, v27, v28
v_mul_f32 v29, -v145, v209
v_fma_f32 v29, -v153, v201, v29
v_fma_f32 v29, -v170, v27, v29
v_fma_f32 v29, v171, v26, v29
v_cvt_pk_bf16_f32 v161, v28, v29
v_lshlrev_b32 v26, 16, v218
v_and_b32 v27, s37, v218
v_mul_f32 v28, v146, v202
v_fma_f32 v28, -v154, v210, v28
v_fma_f32 v28, v172, v26, v28
v_fma_f32 v28, v173, v27, v28
v_mul_f32 v29, -v146, v210
v_fma_f32 v29, -v154, v202, v29
v_fma_f32 v29, -v172, v27, v29
v_fma_f32 v29, v173, v26, v29
v_cvt_pk_bf16_f32 v162, v28, v29
v_lshlrev_b32 v26, 16, v219
v_and_b32 v27, s37, v219
v_mul_f32 v28, v147, v203
v_fma_f32 v28, -v155, v211, v28
v_fma_f32 v28, v174, v26, v28
v_fma_f32 v28, v175, v27, v28
v_mul_f32 v29, -v147, v211
v_fma_f32 v29, -v155, v203, v29
v_fma_f32 v29, -v174, v27, v29
v_fma_f32 v29, v175, v26, v29
v_cvt_pk_bf16_f32 v163, v28, v29
v_lshlrev_b32 v26, 16, v220
v_and_b32 v27, s37, v220
v_mul_f32 v28, v148, v204
v_fma_f32 v28, -v156, v212, v28
v_fma_f32 v28, v176, v26, v28
v_fma_f32 v28, v177, v27, v28
v_mul_f32 v29, -v148, v212
v_fma_f32 v29, -v156, v204, v29
v_fma_f32 v29, -v176, v27, v29
v_fma_f32 v29, v177, v26, v29
v_cvt_pk_bf16_f32 v164, v28, v29
v_lshlrev_b32 v26, 16, v221
v_and_b32 v27, s37, v221
v_mul_f32 v28, v149, v205
v_fma_f32 v28, -v157, v213, v28
v_fma_f32 v28, v178, v26, v28
v_fma_f32 v28, v179, v27, v28
v_mul_f32 v29, -v149, v213
v_fma_f32 v29, -v157, v205, v29
v_fma_f32 v29, -v178, v27, v29
v_fma_f32 v29, v179, v26, v29
v_cvt_pk_bf16_f32 v165, v28, v29
v_lshlrev_b32 v26, 16, v222
v_and_b32 v27, s37, v222
v_mul_f32 v28, v150, v206
v_fma_f32 v28, -v158, v214, v28
v_fma_f32 v28, v180, v26, v28
v_fma_f32 v28, v181, v27, v28
v_mul_f32 v29, -v150, v214
v_fma_f32 v29, -v158, v206, v29
v_fma_f32 v29, -v180, v27, v29
v_fma_f32 v29, v181, v26, v29
v_cvt_pk_bf16_f32 v166, v28, v29
v_lshlrev_b32 v26, 16, v223
v_and_b32 v27, s37, v223
v_mul_f32 v28, v151, v207
v_fma_f32 v28, -v159, v215, v28
v_fma_f32 v28, v182, v26, v28
v_fma_f32 v28, v183, v27, v28
v_mul_f32 v29, -v151, v215
v_fma_f32 v29, -v159, v207, v29
v_fma_f32 v29, -v182, v27, v29
v_fma_f32 v29, v183, v26, v29
v_cvt_pk_bf16_f32 v167, v28, v29
s_branch L_sp2_ret
L_compute:
s_setprio 2
s_cmp_eq_u32 s39, 0
s_cbranch_scc0 L_npc
s_getpc_b64 s[92:93]
L_pc:
s_sub_u32 s92, s92, L_pc - parallel_sum__spectral_gfnet__glu_gated_reglu__prompt_kernel
s_subb_u32 s93, s93, 0
s_lshr_b32 s94, s2, 3
s_and_b32 s94, s94, 7
s_lshl_b32 s94, s94, 12
v_and_b32 v3, 31, v1
v_lshlrev_b32 v3, 7, v3
v_add_u32 v3, s94, v3
s_mov_b32 s95, L_code_end - parallel_sum__spectral_gfnet__glu_gated_reglu__prompt_kernel - 4
v_min_u32 v3, s95, v3
global_load_dword v255, v3, s[92:93]
L_npc:
s_mov_b32 s52, 0xffff0000
v_lshlrev_b32 v122, 4, v1
s_and_b32 s56, s42, 3
s_lshl_b32 s56, s56, 3
s_lshl_b32 s57, s40, 1
s_add_u32 s56, s56, s57
s_lshl_b32 s56, s56, 6
s_lshl_b32 s57, s41, 2
s_add_u32 s56, s56, s57
s_lshr_b32 s57, s42, 2
s_add_u32 s56, s56, s57
s_lshl_b32 s56, s56, 10
s_add_u32 s57, s56, 65536
s_waitcnt lgkmcnt(0)
s_mov_b32 s8, s72
s_and_b32 s9, s73, 0xffff
s_mov_b32 s10, 2097152
s_mov_b32 s11, 0x20000
s_add_u32 s20, s90, 13631488
s_addc_u32 s21, s91, 0
s_and_b32 s21, s21, 0xffff
s_mov_b32 s22, 2097152
s_mov_b32 s23, 0x20000
buffer_load_dwordx4 v[100:103], v122, s[8:11], s56 offen
buffer_load_dwordx4 v[104:107], v122, s[8:11], s57 offen
v_bfe_u32 v122, v9, 1, 3
v_lshlrev_b32 v123, 7, v9
s_lshl_b32 s56, s40, 12
s_xor_b32 s57, s40, 1
s_lshl_b32 s57, s57, 12
v_add_u32 v124, 0, v10
v_xor_b32 v124, v124, v122
v_lshl_add_u32 v124, v124, 4, v123
v_add_u32 v16, s56, v124
v_add_u32 v20, s57, v124
v_add_u32 v124, 2, v10
v_xor_b32 v124, v124, v122
v_lshl_add_u32 v124, v124, 4, v123
v_add_u32 v17, s56, v124
v_add_u32 v21, s57, v124
v_add_u32 v124, 4, v10
v_xor_b32 v124, v124, v122
v_lshl_add_u32 v124, v124, 4, v123
v_add_u32 v18, s56, v124
v_add_u32 v22, s57, v124
v_add_u32 v124, 6, v10
v_xor_b32 v124, v124, v122
v_lshl_add_u32 v124, v124, 4, v123
v_add_u32 v19, s56, v124
v_add_u32 v23, s57, v124
v_bfe_u32 v122, v1, 4, 1
v_mul_u32_u24 v122, 12320, v122
v_bfe_u32 v123, v1, 2, 2
v_lshl_add_u32 v123, v10, 3, v123
v_mul_u32_u24 v123, 192, v123
v_add_u32 v122, v122, v123
v_and_b32 v123, 3, v1
v_lshl_add_u32 v122, v123, 3, v122
s_mul_i32 s56, s46, 96
s_add_u32 s56, s56, 49152
v_add_u32 v24, s56, v122
v_lshlrev_b32 v122, 4, v1
v_add_u32 v25, 122976, v122
v_lshrrev_b32 v112, 1, v9
s_lshl_b32 s56, s42, 4
v_add_u32 v112, s56, v112
v_and_b32 v115, 1, v9
v_cmp_eq_u32 vcc, 0, v112
v_cmp_eq_u32 s[58:59], 1, v115
s_nop 3
s_and_b64 vcc, vcc, s[58:59]
v_mov_b32 v113, 0x100
v_cndmask_b32 v112, v112, v113, vcc
v_cndmask_b32 v115, v115, 0, vcc
v_cvt_f32_u32 v112, v112
v_mul_f32 v112, 0x3b000000, v112
v_cvt_f32_u32 v115, v115
v_mul_f32 v115, 0x3e800000, v115
s_lshr_b32 s56, s41, 1
s_add_u32 s56, s56, 0
s_and_b32 s56, s56, 7
s_lshl_b32 s56, s56, 6
s_lshl_b32 s57, s40, 4
s_add_u32 s56, s56, s57
v_lshlrev_b32 v113, 3, v10
v_add_u32 v113, s56, v113
v_cvt_f32_u32 v113, v113
v_fma_f32 v113, v112, v113, v115
v_mul_f32 v114, 0x42600000, v112
s_lshl_b32 s56, s40, 10
v_add_u32 v116, s56, v25
v_fract_f32 v113, v113
v_cos_f32 v64, v113
v_add_f32 v113, v113, v112
v_cos_f32 v65, v113
v_add_f32 v113, v113, v112
v_cos_f32 v66, v113
v_add_f32 v113, v113, v112
v_cos_f32 v67, v113
v_add_f32 v113, v113, v112
v_cos_f32 v68, v113
v_add_f32 v113, v113, v112
v_cos_f32 v69, v113
v_add_f32 v113, v113, v112
v_cos_f32 v70, v113
v_add_f32 v113, v113, v112
v_cos_f32 v71, v113
v_add_f32 v113, v113, v112
v_add_f32 v113, v113, v114
v_cvt_pk_bf16_f32 v72, v64, v65
v_cvt_pk_bf16_f32 v73, v66, v67
v_cvt_pk_bf16_f32 v74, v68, v69
v_cvt_pk_bf16_f32 v75, v70, v71
ds_write_b128 v116, v[72:75] offset:0
v_fract_f32 v113, v113
v_cos_f32 v64, v113
v_add_f32 v113, v113, v112
v_cos_f32 v65, v113
v_add_f32 v113, v113, v112
v_cos_f32 v66, v113
v_add_f32 v113, v113, v112
v_cos_f32 v67, v113
v_add_f32 v113, v113, v112
v_cos_f32 v68, v113
v_add_f32 v113, v113, v112
v_cos_f32 v69, v113
v_add_f32 v113, v113, v112
v_cos_f32 v70, v113
v_add_f32 v113, v113, v112
v_cos_f32 v71, v113
v_add_f32 v113, v113, v112
v_add_f32 v113, v113, v114
v_cvt_pk_bf16_f32 v72, v64, v65
v_cvt_pk_bf16_f32 v73, v66, v67
v_cvt_pk_bf16_f32 v74, v68, v69
v_cvt_pk_bf16_f32 v75, v70, v71
ds_write_b128 v116, v[72:75] offset:4096
v_fract_f32 v113, v113
v_cos_f32 v64, v113
v_add_f32 v113, v113, v112
v_cos_f32 v65, v113
v_add_f32 v113, v113, v112
v_cos_f32 v66, v113
v_add_f32 v113, v113, v112
v_cos_f32 v67, v113
v_add_f32 v113, v113, v112
v_cos_f32 v68, v113
v_add_f32 v113, v113, v112
v_cos_f32 v69, v113
v_add_f32 v113, v113, v112
v_cos_f32 v70, v113
v_add_f32 v113, v113, v112
v_cos_f32 v71, v113
v_add_f32 v113, v113, v112
v_add_f32 v113, v113, v114
v_cvt_pk_bf16_f32 v72, v64, v65
v_cvt_pk_bf16_f32 v73, v66, v67
v_cvt_pk_bf16_f32 v74, v68, v69
v_cvt_pk_bf16_f32 v75, v70, v71
ds_write_b128 v116, v[72:75] offset:8192
v_mov_b32 v40, 0
v_mov_b32 v41, 0
v_mov_b32 v42, 0
v_mov_b32 v43, 0
s_nop 1
v_mfma_f32_32x32x16_bf16 v[128:143], v[40:43], v[40:43], 0
v_mfma_f32_32x32x16_bf16 v[144:159], v[40:43], v[40:43], 0
v_mfma_f32_32x32x16_bf16 v[160:175], v[40:43], v[40:43], 0
v_mfma_f32_32x32x16_bf16 v[176:191], v[40:43], v[40:43], 0
v_mfma_f32_32x32x16_bf16 v[192:207], v[40:43], v[40:43], 0
v_mfma_f32_32x32x16_bf16 v[208:223], v[40:43], v[40:43], 0
v_mfma_f32_32x32x16_bf16 v[224:239], v[40:43], v[40:43], 0
v_mov_b32 v29, 0
v_mov_b32 v30, 0
v_mov_b32 v31, 0
v_mov_b32 v33, 0
v_mov_b32 v34, 0
v_mov_b32 v35, 0
v_mov_b32 v37, 0
v_mov_b32 v38, 0
v_mov_b32 v39, 0
v_mov_b32 v45, 0
v_mov_b32 v46, 0
v_mov_b32 v47, 0
v_mov_b32 v49, 0
v_mov_b32 v50, 0
v_mov_b32 v51, 0
v_lshlrev_b32 v2, 4, v1
v_lshlrev_b32 v3, 2, v9
v_lshl_add_u32 v3, v10, 14, v3
v_bfe_u32 v122, v1, 4, 1
v_mul_u32_u24 v122, 384, v122
v_and_b32 v123, 15, v1
v_lshl_add_u32 v122, v123, 2, v122
s_mul_i32 s56, s46, 192
s_add_u32 s56, s56, 136800
v_add_u32 v4, s56, v122
v_lshlrev_b32 v122, 3, v9
s_lshl_b32 s56, s40, 8
s_add_u32 s56, s56, 137824
v_add_u32 v5, s56, v122
s_xor_b32 s56, s40, 1
s_lshl_b32 s56, s56, 8
s_add_u32 s56, s56, 137824
v_add_u32 v6, s56, v122
s_cmp_eq_u32 s42, 0
s_cselect_b32 s56, 0x4400, 0
v_mov_b32 v122, s56
v_cmp_eq_u32 vcc, 0, v1
s_nop 1
v_cndmask_b32 v40, 0, v122, vcc
s_mov_b32 s24, s90
s_and_b32 s25, s91, 0xffff
s_mov_b32 s26, 5636096
s_mov_b32 s27, 0x20000
s_add_u32 s28, s90, 6291456
s_addc_u32 s29, s91, 0
s_and_b32 s29, s29, 0xffff
s_mov_b32 s30, 2097152
s_mov_b32 s31, 0x20000
s_waitcnt vmcnt(0)
s_mov_b32 s56, 0x3f803f80
v_dot2_f32_bf16 v96, v100, s56, 0
v_dot2_f32_bf16 v97, v100, v100, 0
v_dot2_f32_bf16 v98, v104, s56, 0
v_dot2_f32_bf16 v99, v104, v104, 0
v_dot2_f32_bf16 v96, v101, s56, v96
v_dot2_f32_bf16 v97, v101, v101, v97
v_dot2_f32_bf16 v98, v105, s56, v98
v_dot2_f32_bf16 v99, v105, v105, v99
v_dot2_f32_bf16 v96, v102, s56, v96
v_dot2_f32_bf16 v97, v102, v102, v97
v_dot2_f32_bf16 v98, v106, s56, v98
v_dot2_f32_bf16 v99, v106, v106, v99
v_dot2_f32_bf16 v96, v103, s56, v96
v_dot2_f32_bf16 v97, v103, v103, v97
v_dot2_f32_bf16 v98, v107, s56, v98
v_dot2_f32_bf16 v99, v107, v107, v99
v_add_f32_dpp v96, v96, v96 row_shr:1 row_mask:0xf bank_mask:0xf bound_ctrl:0
v_add_f32_dpp v97, v97, v97 row_shr:1 row_mask:0xf bank_mask:0xf bound_ctrl:0
v_add_f32_dpp v98, v98, v98 row_shr:1 row_mask:0xf bank_mask:0xf bound_ctrl:0
v_add_f32_dpp v99, v99, v99 row_shr:1 row_mask:0xf bank_mask:0xf bound_ctrl:0
v_add_f32_dpp v96, v96, v96 row_shr:2 row_mask:0xf bank_mask:0xf bound_ctrl:0
v_add_f32_dpp v97, v97, v97 row_shr:2 row_mask:0xf bank_mask:0xf bound_ctrl:0
v_add_f32_dpp v98, v98, v98 row_shr:2 row_mask:0xf bank_mask:0xf bound_ctrl:0
v_add_f32_dpp v99, v99, v99 row_shr:2 row_mask:0xf bank_mask:0xf bound_ctrl:0
v_add_f32_dpp v96, v96, v96 row_shr:4 row_mask:0xf bank_mask:0xf bound_ctrl:0
v_add_f32_dpp v97, v97, v97 row_shr:4 row_mask:0xf bank_mask:0xf bound_ctrl:0
v_add_f32_dpp v98, v98, v98 row_shr:4 row_mask:0xf bank_mask:0xf bound_ctrl:0
v_add_f32_dpp v99, v99, v99 row_shr:4 row_mask:0xf bank_mask:0xf bound_ctrl:0
v_add_f32_dpp v96, v96, v96 row_shr:8 row_mask:0xf bank_mask:0xf bound_ctrl:0
v_add_f32_dpp v97, v97, v97 row_shr:8 row_mask:0xf bank_mask:0xf bound_ctrl:0
v_add_f32_dpp v98, v98, v98 row_shr:8 row_mask:0xf bank_mask:0xf bound_ctrl:0
v_add_f32_dpp v99, v99, v99 row_shr:8 row_mask:0xf bank_mask:0xf bound_ctrl:0
v_add_f32_dpp v96, v96, v96 row_bcast:15 row_mask:0xa bank_mask:0xf
v_add_f32_dpp v97, v97, v97 row_bcast:15 row_mask:0xa bank_mask:0xf
v_add_f32_dpp v98, v98, v98 row_bcast:15 row_mask:0xa bank_mask:0xf
v_add_f32_dpp v99, v99, v99 row_bcast:15 row_mask:0xa bank_mask:0xf
v_add_f32_dpp v96, v96, v96 row_bcast:31 row_mask:0xc bank_mask:0xf
v_add_f32_dpp v97, v97, v97 row_bcast:31 row_mask:0xc bank_mask:0xf
v_add_f32_dpp v98, v98, v98 row_bcast:31 row_mask:0xc bank_mask:0xf
v_add_f32_dpp v99, v99, v99 row_bcast:31 row_mask:0xc bank_mask:0xf
s_nop 0
v_mov_b32_dpp v122, v98 row_shl:1 row_mask:0xf bank_mask:0xf bound_ctrl:0
v_mov_b32_dpp v123, v99 row_shl:1 row_mask:0xf bank_mask:0xf bound_ctrl:0
v_cmp_eq_u32 vcc, 62, v1
s_nop 1
v_cndmask_b32 v96, v96, v122, vcc
v_cndmask_b32 v97, v97, v123, vcc
v_mul_f32 v96, 0x3b000000, v96
v_mul_f32 v97, 0x3b000000, v97
v_fma_f32 v97, -v96, v96, v97
v_max_f32 v97, 0, v97
v_cvt_pk_bf16_f32 v124, v97, v97
v_and_b32 v124, s52, v124
v_add_f32 v124, 0x3727c5ac, v124
v_cvt_pk_bf16_f32 v124, v124, v124
v_and_b32 v124, s52, v124
v_sqrt_f32 v124, v124
s_nop 0
v_cvt_pk_bf16_f32 v124, v124, v124
v_and_b32 v124, s52, v124
v_rcp_f32 v99, v124
v_cvt_pk_bf16_f32 v98, -v96, -v96
s_lshl_b32 s56, s41, 4
s_add_u32 s56, s56, s42
s_lshl_b32 s56, s56, 7
s_lshl_b32 s57, s40, 4
s_add_u32 s56, s56, s57
s_add_u32 s56, s56, 524288
v_sub_u32 v123, 63, v1
v_lshlrev_b32 v123, 3, v123
s_mov_b32 exec_lo, 0
s_mov_b32 exec_hi, 0xc0000000
buffer_store_dwordx2 v[98:99], v123, s[20:23], s56 offen sc1
s_mov_b64 exec, -1
s_waitcnt lgkmcnt(0)
s_barrier
ds_read_b128 v[64:67], v16
ds_read_b64_tr_b16 v[80:81], v24 offset:0
ds_read_b64_tr_b16 v[82:83], v24 offset:768
ds_read_b128 v[68:71], v20
ds_read_b64_tr_b16 v[84:85], v24 offset:32
ds_read_b64_tr_b16 v[86:87], v24 offset:800
ds_read_b64_tr_b16 v[88:89], v24 offset:64
ds_read_b64_tr_b16 v[90:91], v24 offset:832
ds_read_b128 v[104:107], v25 offset:0
s_mov_b32 s47, 0
s_mov_b32 s48, 0
s_mov_b32 s49, 16384
s_mov_b32 s50, 24608
s_mov_b32 s51, 4096
s_mov_b32 s53, 4294934528
s_mov_b32 s54, 4294918080
s_mov_b32 s55, 4294959104
L_ab:
s_waitcnt lgkmcnt(6)
v_mfma_f32_32x32x16_bf16 v[128:143], v[80:83], v[64:67], v[128:143]
ds_read_b128 v[72:75], v17
ds_read_b64_tr_b16 v[92:93], v24 offset:3072
ds_read_b64_tr_b16 v[94:95], v24 offset:3840
s_waitcnt lgkmcnt(8)
v_mfma_f32_32x32x16_bf16 v[144:159], v[80:83], v[68:71], v[144:159]
ds_read_b128 v[76:79], v21
ds_read_b64_tr_b16 v[96:97], v24 offset:3104
s_waitcnt lgkmcnt(8)
v_mfma_f32_32x32x16_bf16 v[160:175], v[84:87], v[64:67], v[160:175]
ds_read_b64_tr_b16 v[98:99], v24 offset:3872
ds_read_b64_tr_b16 v[100:101], v24 offset:3136
v_mfma_f32_32x32x16_bf16 v[176:191], v[84:87], v[68:71], v[176:191]
ds_read_b64_tr_b16 v[102:103], v24 offset:3904
ds_read_b128 v[108:111], v25 offset:1024
s_waitcnt lgkmcnt(10)
v_mfma_f32_32x32x16_bf16 v[192:207], v[88:91], v[64:67], v[192:207]
v_mfma_f32_32x32x16_bf16 v[208:223], v[88:91], v[68:71], v[208:223]
v_add_u32 v16, s49, v16
v_add_u32 v20, s49, v20
s_waitcnt lgkmcnt(9)
v_mfma_f32_32x32x16_bf16 v[224:239], v[104:107], v[64:67], v[224:239]
s_waitcnt lgkmcnt(6)
v_mfma_f32_32x32x16_bf16 v[128:143], v[92:95], v[72:75], v[128:143]
ds_read_b128 v[64:67], v18
ds_read_b64_tr_b16 v[80:81], v24 offset:6144
ds_read_b64_tr_b16 v[82:83], v24 offset:6912
s_waitcnt lgkmcnt(8)
v_mfma_f32_32x32x16_bf16 v[144:159], v[92:95], v[76:79], v[144:159]
ds_read_b128 v[68:71], v22
ds_read_b64_tr_b16 v[84:85], v24 offset:6176
s_waitcnt lgkmcnt(8)
v_mfma_f32_32x32x16_bf16 v[160:175], v[96:99], v[72:75], v[160:175]
ds_read_b64_tr_b16 v[86:87], v24 offset:6944
ds_read_b64_tr_b16 v[88:89], v24 offset:6208
v_mfma_f32_32x32x16_bf16 v[176:191], v[96:99], v[76:79], v[176:191]
ds_read_b64_tr_b16 v[90:91], v24 offset:6976
ds_read_b128 v[104:107], v25 offset:2048
s_waitcnt lgkmcnt(10)
v_mfma_f32_32x32x16_bf16 v[192:207], v[100:103], v[72:75], v[192:207]
v_mfma_f32_32x32x16_bf16 v[208:223], v[100:103], v[76:79], v[208:223]
v_add_u32 v17, s49, v17
v_add_u32 v21, s49, v21
s_waitcnt lgkmcnt(9)
v_mfma_f32_32x32x16_bf16 v[224:239], v[108:111], v[72:75], v[224:239]
s_waitcnt lgkmcnt(6)
v_mfma_f32_32x32x16_bf16 v[128:143], v[80:83], v[64:67], v[128:143]
ds_read_b128 v[72:75], v19
ds_read_b64_tr_b16 v[92:93], v24 offset:9216
ds_read_b64_tr_b16 v[94:95], v24 offset:9984
s_waitcnt lgkmcnt(8)
v_mfma_f32_32x32x16_bf16 v[144:159], v[80:83], v[68:71], v[144:159]
ds_read_b128 v[76:79], v23
ds_read_b64_tr_b16 v[96:97], v24 offset:9248
s_waitcnt lgkmcnt(8)
v_mfma_f32_32x32x16_bf16 v[160:175], v[84:87], v[64:67], v[160:175]
ds_read_b64_tr_b16 v[98:99], v24 offset:10016
ds_read_b64_tr_b16 v[100:101], v24 offset:9280
v_mfma_f32_32x32x16_bf16 v[176:191], v[84:87], v[68:71], v[176:191]
ds_read_b64_tr_b16 v[102:103], v24 offset:10048
ds_read_b128 v[108:111], v25 offset:3072
s_waitcnt lgkmcnt(10)
v_mfma_f32_32x32x16_bf16 v[192:207], v[88:91], v[64:67], v[192:207]
v_mfma_f32_32x32x16_bf16 v[208:223], v[88:91], v[68:71], v[208:223]
v_add_u32 v18, s49, v18
v_add_u32 v22, s49, v22
s_waitcnt lgkmcnt(9)
v_mfma_f32_32x32x16_bf16 v[224:239], v[104:107], v[64:67], v[224:239]
v_add_u32 v24, s50, v24
v_add_u32 v25, s51, v25
s_waitcnt vmcnt(0) lgkmcnt(0)
v_mfma_f32_32x32x16_bf16 v[128:143], v[92:95], v[72:75], v[128:143]
s_barrier
v_mfma_f32_32x32x16_bf16 v[144:159], v[92:95], v[76:79], v[144:159]
ds_read_b128 v[64:67], v16
ds_read_b64_tr_b16 v[80:81], v24 offset:0
ds_read_b64_tr_b16 v[82:83], v24 offset:768
v_mfma_f32_32x32x16_bf16 v[160:175], v[96:99], v[72:75], v[160:175]
ds_read_b128 v[68:71], v20
ds_read_b64_tr_b16 v[84:85], v24 offset:32
v_mfma_f32_32x32x16_bf16 v[176:191], v[96:99], v[76:79], v[176:191]
ds_read_b64_tr_b16 v[86:87], v24 offset:800
ds_read_b64_tr_b16 v[88:89], v24 offset:64
v_mfma_f32_32x32x16_bf16 v[192:207], v[100:103], v[72:75], v[192:207]
ds_read_b64_tr_b16 v[90:91], v24 offset:832
ds_read_b128 v[104:107], v25 offset:0
v_mfma_f32_32x32x16_bf16 v[208:223], v[100:103], v[76:79], v[208:223]
v_add_u32 v19, s49, v19
v_add_u32 v23, s49, v23
s_add_u32 s48, s48, 1
s_cmp_eq_u32 s48, 3
s_cselect_b32 s48, 0, s48
s_cmp_eq_u32 s48, 2
s_cselect_b32 s49, s53, 16384
s_cselect_b32 s50, s54, 24608
s_cselect_b32 s51, s55, 4096
v_mfma_f32_32x32x16_bf16 v[224:239], v[108:111], v[72:75], v[224:239]
s_add_u32 s47, s47, 1
s_cmp_lt_u32 s47, 8
s_cbranch_scc1 L_ab
s_waitcnt lgkmcnt(0)
ds_read_b64 v[12:13], v5
ds_read_b64 v[14:15], v6
ds_read_b32 v122, v4 offset:0
ds_read_b32 v123, v4 offset:64
ds_read_b32 v124, v4 offset:128
v_cmp_gt_u32 vcc, 32, v1
s_waitcnt lgkmcnt(3)
v_mov_b32 v44, v12
v_mov_b32 v48, v14
s_waitcnt lgkmcnt(0)
v_cndmask_b32 v28, 0, v122, vcc
v_cndmask_b32 v32, 0, v123, vcc
v_cndmask_b32 v36, 0, v124, vcc
v_mfma_f32_32x32x16_bf16 v[128:143], v[28:31], v[44:47], v[128:143]
s_lshl_b32 s59, s43, 1
s_mul_i32 s57, s46, 3
s_add_u32 s59, s59, s57
v_mfma_f32_32x32x16_bf16 v[144:159], v[28:31], v[48:51], v[144:159]
s_mul_i32 s57, s44, 86
s_add_u32 s57, s57, s59
s_lshl_b32 s57, s57, 10
s_xor_b32 s58, s44, 1
s_mul_i32 s58, s58, 86
s_add_u32 s58, s58, s59
s_lshl_b32 s58, s58, 10
v_mfma_f32_32x32x16_bf16 v[160:175], v[32:35], v[44:47], v[160:175]
s_mul_i32 s53, s42, 21846
s_lshr_b32 s53, s53, 16
s_mul_i32 s53, s53, 3
s_sub_u32 s53, s42, s53
s_lshl_b32 s53, s53, 1
s_add_u32 s53, s53, s46
s_cmp_eq_u32 s53, 2
s_cselect_b32 s54, 2147418112, s57
s_cselect_b32 s55, 2147418112, s58
v_mfma_f32_32x32x16_bf16 v[176:191], v[32:35], v[48:51], v[176:191]
v_mfma_f32_32x32x16_bf16 v[192:207], v[36:39], v[44:47], v[192:207]
v_mfma_f32_32x32x16_bf16 v[208:223], v[36:39], v[48:51], v[208:223]
v_mfma_f32_32x32x16_bf16 v[224:239], v[40:43], v[44:47], v[224:239]
v_max_f32 v128, 0, v128
v_max_f32 v129, 0, v129
v_max_f32 v130, 0, v130
v_max_f32 v131, 0, v131
v_max_f32 v132, 0, v132
v_max_f32 v133, 0, v133
v_max_f32 v134, 0, v134
v_max_f32 v135, 0, v135
v_mul_f32 v128, v128, v136
v_mul_f32 v129, v129, v137
v_mul_f32 v130, v130, v138
v_mul_f32 v131, v131, v139
v_mul_f32 v132, v132, v140
v_mul_f32 v133, v133, v141
v_mul_f32 v134, v134, v142
v_mul_f32 v135, v135, v143
v_cvt_pk_bf16_f32 v92, v128, v129
v_cvt_pk_bf16_f32 v93, v130, v131
v_cvt_pk_bf16_f32 v94, v132, v133
v_cvt_pk_bf16_f32 v95, v134, v135
buffer_store_dwordx4 v[92:95], v2, s[24:27], s54 offen offset:0 sc1
v_max_f32 v144, 0, v144
v_max_f32 v145, 0, v145
v_max_f32 v146, 0, v146
v_max_f32 v147, 0, v147
v_max_f32 v148, 0, v148
v_max_f32 v149, 0, v149
v_max_f32 v150, 0, v150
v_max_f32 v151, 0, v151
v_mul_f32 v144, v144, v152
v_mul_f32 v145, v145, v153
v_mul_f32 v146, v146, v154
v_mul_f32 v147, v147, v155
v_mul_f32 v148, v148, v156
v_mul_f32 v149, v149, v157
v_mul_f32 v150, v150, v158
v_mul_f32 v151, v151, v159
v_cvt_pk_bf16_f32 v96, v144, v145
v_cvt_pk_bf16_f32 v97, v146, v147
v_cvt_pk_bf16_f32 v98, v148, v149
v_cvt_pk_bf16_f32 v99, v150, v151
buffer_store_dwordx4 v[96:99], v2, s[24:27], s55 offen offset:0 sc1
v_max_f32 v160, 0, v160
v_max_f32 v161, 0, v161
v_max_f32 v162, 0, v162
v_max_f32 v163, 0, v163
v_max_f32 v164, 0, v164
v_max_f32 v165, 0, v165
v_max_f32 v166, 0, v166
v_max_f32 v167, 0, v167
v_mul_f32 v160, v160, v168
v_mul_f32 v161, v161, v169
v_mul_f32 v162, v162, v170
v_mul_f32 v163, v163, v171
v_mul_f32 v164, v164, v172
v_mul_f32 v165, v165, v173
v_mul_f32 v166, v166, v174
v_mul_f32 v167, v167, v175
v_cvt_pk_bf16_f32 v100, v160, v161
v_cvt_pk_bf16_f32 v101, v162, v163
v_cvt_pk_bf16_f32 v102, v164, v165
v_cvt_pk_bf16_f32 v103, v166, v167
buffer_store_dwordx4 v[100:103], v2, s[24:27], s54 offen offset:1024 sc1
v_max_f32 v176, 0, v176
v_max_f32 v177, 0, v177
v_max_f32 v178, 0, v178
v_max_f32 v179, 0, v179
v_max_f32 v180, 0, v180
v_max_f32 v181, 0, v181
v_max_f32 v182, 0, v182
v_max_f32 v183, 0, v183
v_mul_f32 v176, v176, v184
v_mul_f32 v177, v177, v185
v_mul_f32 v178, v178, v186
v_mul_f32 v179, v179, v187
v_mul_f32 v180, v180, v188
v_mul_f32 v181, v181, v189
v_mul_f32 v182, v182, v190
v_mul_f32 v183, v183, v191
v_cvt_pk_bf16_f32 v72, v176, v177
v_cvt_pk_bf16_f32 v73, v178, v179
v_cvt_pk_bf16_f32 v74, v180, v181
v_cvt_pk_bf16_f32 v75, v182, v183
buffer_store_dwordx4 v[72:75], v2, s[24:27], s55 offen offset:1024 sc1
v_max_f32 v192, 0, v192
v_max_f32 v193, 0, v193
v_max_f32 v194, 0, v194
v_max_f32 v195, 0, v195
v_max_f32 v196, 0, v196
v_max_f32 v197, 0, v197
v_max_f32 v198, 0, v198
v_max_f32 v199, 0, v199
v_mul_f32 v192, v192, v200
v_mul_f32 v193, v193, v201
v_mul_f32 v194, v194, v202
v_mul_f32 v195, v195, v203
v_mul_f32 v196, v196, v204
v_mul_f32 v197, v197, v205
v_mul_f32 v198, v198, v206
v_mul_f32 v199, v199, v207
v_cvt_pk_bf16_f32 v76, v192, v193
v_cvt_pk_bf16_f32 v77, v194, v195
v_cvt_pk_bf16_f32 v78, v196, v197
v_cvt_pk_bf16_f32 v79, v198, v199
buffer_store_dwordx4 v[76:79], v2, s[24:27], s57 offen offset:2048 sc1
v_max_f32 v208, 0, v208
v_max_f32 v209, 0, v209
v_max_f32 v210, 0, v210
v_max_f32 v211, 0, v211
v_max_f32 v212, 0, v212
v_max_f32 v213, 0, v213
v_max_f32 v214, 0, v214
v_max_f32 v215, 0, v215
v_mul_f32 v208, v208, v216
v_mul_f32 v209, v209, v217
v_mul_f32 v210, v210, v218
v_mul_f32 v211, v211, v219
v_mul_f32 v212, v212, v220
v_mul_f32 v213, v213, v221
v_mul_f32 v214, v214, v222
v_mul_f32 v215, v215, v223
v_cvt_pk_bf16_f32 v104, v208, v209
v_cvt_pk_bf16_f32 v105, v210, v211
v_cvt_pk_bf16_f32 v106, v212, v213
v_cvt_pk_bf16_f32 v107, v214, v215
buffer_store_dwordx4 v[104:107], v2, s[24:27], s58 offen offset:2048 sc1
s_lshl_b32 s56, s42, 17
s_lshl_b32 s57, s44, 7
s_add_u32 s56, s56, s57
v_mul_f32 v224, v13, v224
v_mul_f32 v225, v13, v225
v_cvt_pk_bf16_f32 v224, v224, v225
s_add_u32 s57, s56, 0
buffer_store_dword v224, v3, s[28:31], s57 offen sc1
v_mul_f32 v226, v13, v226
v_mul_f32 v227, v13, v227
v_cvt_pk_bf16_f32 v226, v226, v227
s_add_u32 s57, s56, 8192
buffer_store_dword v226, v3, s[28:31], s57 offen sc1
v_mul_f32 v228, v13, v228
v_mul_f32 v229, v13, v229
v_cvt_pk_bf16_f32 v228, v228, v229
s_add_u32 s57, s56, 32768
buffer_store_dword v228, v3, s[28:31], s57 offen sc1
v_mul_f32 v230, v13, v230
v_mul_f32 v231, v13, v231
v_cvt_pk_bf16_f32 v230, v230, v231
s_add_u32 s57, s56, 40960
buffer_store_dword v230, v3, s[28:31], s57 offen sc1
v_mul_f32 v232, v13, v232
v_mul_f32 v233, v13, v233
v_cvt_pk_bf16_f32 v232, v232, v233
s_add_u32 s57, s56, 65536
buffer_store_dword v232, v3, s[28:31], s57 offen sc1
v_mul_f32 v234, v13, v234
v_mul_f32 v235, v13, v235
v_cvt_pk_bf16_f32 v234, v234, v235
s_add_u32 s57, s56, 73728
buffer_store_dword v234, v3, s[28:31], s57 offen sc1
v_mul_f32 v236, v13, v236
v_mul_f32 v237, v13, v237
v_cvt_pk_bf16_f32 v236, v236, v237
s_add_u32 s57, s56, 98304
buffer_store_dword v236, v3, s[28:31], s57 offen sc1
v_mul_f32 v238, v13, v238
v_mul_f32 v239, v13, v239
v_cvt_pk_bf16_f32 v238, v238, v239
s_add_u32 s57, s56, 106496
buffer_store_dword v238, v3, s[28:31], s57 offen sc1
s_load_dwordx2 s[80:81], s[0:1], 56
s_and_b32 s56, s2, 7
s_lshr_b32 s57, s2, 3
s_lshl_b32 s85, s56, 2
s_and_b32 s58, s57, 3
s_add_u32 s85, s85, s58
s_lshr_b32 s101, s57, 2
v_lshrrev_b32 v2, 3, v1
v_and_b32 v3, 7, v1
v_bfe_u32 v4, v1, 4, 1
v_lshlrev_b32 v4, 2, v4
v_xor_b32 v3, v3, v4
v_lshlrev_b32 v3, 4, v3
v_lshl_add_u32 v45, v2, 10, v3
v_lshlrev_b32 v47, 4, v1
s_lshl_b32 s47, s40, 14
s_lshl_b32 s56, s101, 7
s_add_u32 s47, s47, s56
s_mul_i32 s48, s85, 172
s_add_u32 s48, s48, s40
s_lshl_b32 s48, s48, 10
s_add_u32 s49, s48, 88064
s_lshl_b32 s50, s40, 12
s_lshl_b32 s56, s85, 1
s_add_u32 s56, s56, s46
s_and_b32 s57, s56, 3
s_lshr_b32 s56, s56, 2
s_lshl_b32 s56, s56, 4
s_lshl_b32 s57, s57, 2
s_add_u32 s56, s56, s57
s_lshl_b32 s56, s56, 7
s_add_u32 s55, s56, 524292
v_lshrrev_b32 v2, 3, v9
v_lshlrev_b32 v2, 7, v2
v_and_b32 v3, 7, v9
v_lshl_add_u32 v44, v3, 3, v2
v_bfe_u32 v2, v1, 2, 2
v_lshl_add_u32 v3, v10, 2, v2
v_lshlrev_b32 v3, 7, v3
v_bfe_u32 v4, v1, 3, 1
v_bfe_u32 v5, v1, 4, 1
v_and_b32 v6, 3, v1
v_xor_b32 v7, s45, v4
v_lshl_add_u32 v7, v7, 6, v3
v_and_b32 v8, 1, v6
v_lshlrev_b32 v8, 5, v8
v_lshl_add_u32 v8, v5, 4, v8
v_lshrrev_b32 v2, 1, v6
v_lshl_add_u32 v8, v2, 3, v8
v_add_u32 v40, v7, v8
v_xor_b32 v7, s46, v4
v_lshl_add_u32 v7, v7, 6, v3
v_lshlrev_b32 v8, 5, v5
v_lshl_add_u32 v8, v6, 3, v8
v_add_u32 v42, v7, v8
s_lshl_b32 s56, s46, 10
s_add_u32 s56, s56, 2048
v_add_u32 v41, s56, v47
s_lshl_b32 s56, s45, 10
s_add_u32 s56, s56, 2048
v_add_u32 v43, s56, v47
v_add_u32 v36, 0x10000, v40
v_add_u32 v37, 0x10000, v41
v_add_u32 v38, 0x10000, v42
v_add_u32 v39, 0x10000, v43
v_mov_b32 v80, 0
v_mov_b32 v81, 0
v_mov_b32 v82, 0
v_mov_b32 v83, 0
v_mov_b32 v84, 0
v_mov_b32 v85, 0
v_mov_b32 v86, 0
v_mov_b32 v87, 0
v_mov_b32 v88, 0
v_mov_b32 v89, 0
v_mov_b32 v90, 0
v_mov_b32 v91, 0
v_mov_b32 v92, 0
v_mov_b32 v93, 0
v_mov_b32 v94, 0
v_mov_b32 v95, 0
v_lshrrev_b32 v2, 3, v1
s_lshl_b32 s56, s39, 3
v_add_u32 v2, s56, v2
v_and_b32 v3, 31, v2
v_lshrrev_b32 v4, 5, v2
v_lshlrev_b32 v3, 16, v3
v_lshl_add_u32 v3, v4, 10, v3
v_and_b32 v4, 7, v1
v_lshl_add_u32 v3, v4, 4, v3
s_lshl_b32 s56, s85, 11
s_lshl_b32 s57, s101, 7
s_add_u32 s56, s56, s57
v_add_u32 v12, s56, v3
v_mul_u32_u24 v13, 272, v2
v_lshl_add_u32 v13, v4, 5, v13
s_mov_b32 s8, s78
s_and_b32 s9, s79, 0xffff
s_mov_b32 s10, 1409024
s_mov_b32 s11, 0x20000
s_waitcnt vmcnt(0) lgkmcnt(0)
s_mov_b32 s24, s72
s_and_b32 s25, s73, 0xffff
s_mov_b32 s26, 2097152
s_mov_b32 s27, 0x20000
s_mov_b32 s28, s80
s_and_b32 s29, s81, 0xffff
s_mov_b32 s30, 2097152
s_mov_b32 s31, 0x20000
s_mov_b32 s12, s90
s_and_b32 s13, s91, 0xffff
s_mov_b32 s14, 5636096
s_mov_b32 s15, 0x20000
s_barrier
v_bfe_u32 v224, v9, 2, 1
v_lshlrev_b32 v224, 4, v224
v_lshrrev_b32 v225, 3, v9
v_lshl_add_u32 v224, v225, 2, v224
v_and_b32 v225, 3, v9
v_add_u32 v224, v224, v225
s_lshl_b32 s56, s101, 6
s_lshl_b32 s57, s45, 5
s_add_u32 s56, s56, s57
v_add_u32 v224, s56, v224
v_cvt_f32_u32 v224, v224
v_mul_f32 v224, 0x3b000000, v224
v_lshlrev_b32 v225, 1, v10
v_cvt_f32_u32 v225, v225
v_mul_f32 v225, v225, v224
v_mul_f32 v227, 0x41000000, v224
s_add_u32 s51, s47, 0
s_add_u32 m0, s50, 0
s_nop 0
buffer_load_dwordx4 v45, s[8:11], s51 offen lds
v_cos_f32 v228, v225
v_sin_f32 v229, v225
v_add_f32 v226, v225, v224
v_cos_f32 v230, v226
v_sin_f32 v231, v226
v_fma_f32 v226, 4.0, v224, v225
v_cos_f32 v232, v226
v_sin_f32 v233, v226
v_add_f32 v226, v226, v224
v_cos_f32 v234, v226
v_sin_f32 v235, v226
v_add_f32 v225, v225, v227
v_cmp_gt_u32 vcc, 32, v1
v_and_b32 v226, 1, v9
v_lshlrev_b32 v226, 31, v226
v_xor_b32 v226, 0xbf000000, v226
v_cndmask_b32 v228, v228, 0.5, vcc
v_cndmask_b32 v229, v229, v226, vcc
v_cvt_pk_bf16_f32 v96, v228, v229
v_cvt_pk_bf16_f32 v97, v230, v231
v_cvt_pk_bf16_f32 v98, v232, v233
v_cvt_pk_bf16_f32 v99, v234, v235
v_cos_f32 v228, v225
v_sin_f32 v229, v225
v_add_f32 v226, v225, v224
v_cos_f32 v230, v226
v_sin_f32 v231, v226
v_fma_f32 v226, 4.0, v224, v225
v_cos_f32 v232, v226
v_sin_f32 v233, v226
v_add_f32 v226, v226, v224
v_cos_f32 v234, v226
v_sin_f32 v235, v226
s_addk_i32 s51, 8192
s_addk_i32 m0, 1024
s_nop 0
buffer_load_dwordx4 v45, s[8:11], s51 offen lds
v_add_f32 v225, v225, v227
v_cvt_pk_bf16_f32 v100, v228, v229
v_cvt_pk_bf16_f32 v101, v230, v231
v_cvt_pk_bf16_f32 v102, v232, v233
v_cvt_pk_bf16_f32 v103, v234, v235
v_cos_f32 v228, v225
v_sin_f32 v229, v225
v_add_f32 v226, v225, v224
v_cos_f32 v230, v226
v_sin_f32 v231, v226
v_fma_f32 v226, 4.0, v224, v225
v_cos_f32 v232, v226
v_sin_f32 v233, v226
v_add_f32 v226, v226, v224
v_cos_f32 v234, v226
v_sin_f32 v235, v226
v_add_f32 v225, v225, v227
v_cvt_pk_bf16_f32 v104, v228, v229
v_cvt_pk_bf16_f32 v105, v230, v231
v_cvt_pk_bf16_f32 v106, v232, v233
v_cvt_pk_bf16_f32 v107, v234, v235
v_cos_f32 v228, v225
v_sin_f32 v229, v225
v_add_f32 v226, v225, v224
v_cos_f32 v230, v226
v_sin_f32 v231, v226
v_fma_f32 v226, 4.0, v224, v225
v_cos_f32 v232, v226
v_sin_f32 v233, v226
v_add_f32 v226, v226, v224
v_cos_f32 v234, v226
v_sin_f32 v235, v226
s_add_u32 s51, s47, 65536
s_add_u32 m0, s50, 16384
s_nop 0
buffer_load_dwordx4 v45, s[8:11], s51 offen lds
v_add_f32 v225, v225, v227
v_cvt_pk_bf16_f32 v108, v228, v229
v_cvt_pk_bf16_f32 v109, v230, v231
v_cvt_pk_bf16_f32 v110, v232, v233
v_cvt_pk_bf16_f32 v111, v234, v235
v_cos_f32 v228, v225
v_sin_f32 v229, v225
v_add_f32 v226, v225, v224
v_cos_f32 v230, v226
v_sin_f32 v231, v226
v_fma_f32 v226, 4.0, v224, v225
v_cos_f32 v232, v226
v_sin_f32 v233, v226
v_add_f32 v226, v226, v224
v_cos_f32 v234, v226
v_sin_f32 v235, v226
v_add_f32 v225, v225, v227
v_cvt_pk_bf16_f32 v112, v228, v229
v_cvt_pk_bf16_f32 v113, v230, v231
v_cvt_pk_bf16_f32 v114, v232, v233
v_cvt_pk_bf16_f32 v115, v234, v235
v_cos_f32 v228, v225
v_sin_f32 v229, v225
v_add_f32 v226, v225, v224
v_cos_f32 v230, v226
v_sin_f32 v231, v226
v_fma_f32 v226, 4.0, v224, v225
v_cos_f32 v232, v226
v_sin_f32 v233, v226
v_add_f32 v226, v226, v224
v_cos_f32 v234, v226
v_sin_f32 v235, v226
v_add_f32 v225, v225, v227
s_addk_i32 s51, 8192
s_addk_i32 m0, 1024
s_nop 0
buffer_load_dwordx4 v45, s[8:11], s51 offen lds
v_cvt_pk_bf16_f32 v116, v228, v229
v_cvt_pk_bf16_f32 v117, v230, v231
v_cvt_pk_bf16_f32 v118, v232, v233
v_cvt_pk_bf16_f32 v119, v234, v235
v_cos_f32 v228, v225
v_sin_f32 v229, v225
v_add_f32 v226, v225, v224
v_cos_f32 v230, v226
v_sin_f32 v231, v226
v_fma_f32 v226, 4.0, v224, v225
v_cos_f32 v232, v226
v_sin_f32 v233, v226
v_add_f32 v226, v226, v224
v_cos_f32 v234, v226
v_sin_f32 v235, v226
v_add_f32 v225, v225, v227
v_cvt_pk_bf16_f32 v120, v228, v229
v_cvt_pk_bf16_f32 v121, v230, v231
v_cvt_pk_bf16_f32 v122, v232, v233
v_cvt_pk_bf16_f32 v123, v234, v235
v_cos_f32 v228, v225
v_sin_f32 v229, v225
v_add_f32 v226, v225, v224
v_cos_f32 v230, v226
v_sin_f32 v231, v226
v_fma_f32 v226, 4.0, v224, v225
v_cos_f32 v232, v226
v_sin_f32 v233, v226
v_add_f32 v226, v226, v224
v_cos_f32 v234, v226
v_sin_f32 v235, v226
v_add_f32 v225, v225, v227
s_add_u32 s51, s47, 131072
s_add_u32 m0, s50, 32768
s_nop 0
buffer_load_dwordx4 v45, s[8:11], s51 offen lds
v_cvt_pk_bf16_f32 v124, v228, v229
v_cvt_pk_bf16_f32 v125, v230, v231
v_cvt_pk_bf16_f32 v126, v232, v233
v_cvt_pk_bf16_f32 v127, v234, v235
v_cos_f32 v228, v225
v_sin_f32 v229, v225
v_add_f32 v226, v225, v224
v_cos_f32 v230, v226
v_sin_f32 v231, v226
v_fma_f32 v226, 4.0, v224, v225
v_cos_f32 v232, v226
v_sin_f32 v233, v226
v_add_f32 v226, v226, v224
v_cos_f32 v234, v226
v_sin_f32 v235, v226
v_add_f32 v225, v225, v227
v_cvt_pk_bf16_f32 v128, v228, v229
v_cvt_pk_bf16_f32 v129, v230, v231
v_cvt_pk_bf16_f32 v130, v232, v233
v_cvt_pk_bf16_f32 v131, v234, v235
v_cos_f32 v228, v225
v_sin_f32 v229, v225
v_add_f32 v226, v225, v224
v_cos_f32 v230, v226
v_sin_f32 v231, v226
v_fma_f32 v226, 4.0, v224, v225
v_cos_f32 v232, v226
v_sin_f32 v233, v226
v_add_f32 v226, v226, v224
v_cos_f32 v234, v226
v_sin_f32 v235, v226
v_add_f32 v225, v225, v227
v_cvt_pk_bf16_f32 v132, v228, v229
s_addk_i32 s51, 8192
s_addk_i32 m0, 1024
s_nop 0
buffer_load_dwordx4 v45, s[8:11], s51 offen lds
v_cvt_pk_bf16_f32 v133, v230, v231
v_cvt_pk_bf16_f32 v134, v232, v233
v_cvt_pk_bf16_f32 v135, v234, v235
v_cos_f32 v228, v225
v_sin_f32 v229, v225
v_add_f32 v226, v225, v224
v_cos_f32 v230, v226
v_sin_f32 v231, v226
v_fma_f32 v226, 4.0, v224, v225
v_cos_f32 v232, v226
v_sin_f32 v233, v226
v_add_f32 v226, v226, v224
v_cos_f32 v234, v226
v_sin_f32 v235, v226
v_add_f32 v225, v225, v227
v_cvt_pk_bf16_f32 v136, v228, v229
v_cvt_pk_bf16_f32 v137, v230, v231
v_cvt_pk_bf16_f32 v138, v232, v233
v_cvt_pk_bf16_f32 v139, v234, v235
v_cos_f32 v228, v225
v_sin_f32 v229, v225
v_add_f32 v226, v225, v224
v_cos_f32 v230, v226
v_sin_f32 v231, v226
v_fma_f32 v226, 4.0, v224, v225
v_cos_f32 v232, v226
v_sin_f32 v233, v226
v_add_f32 v226, v226, v224
v_cos_f32 v234, v226
v_sin_f32 v235, v226
v_add_f32 v225, v225, v227
v_cvt_pk_bf16_f32 v140, v228, v229
s_add_u32 s51, s47, 196608
s_add_u32 m0, s50, 49152
s_nop 0
buffer_load_dwordx4 v45, s[8:11], s51 offen lds
v_cvt_pk_bf16_f32 v141, v230, v231
v_cvt_pk_bf16_f32 v142, v232, v233
v_cvt_pk_bf16_f32 v143, v234, v235
v_cos_f32 v228, v225
v_sin_f32 v229, v225
v_add_f32 v226, v225, v224
v_cos_f32 v230, v226
v_sin_f32 v231, v226
v_fma_f32 v226, 4.0, v224, v225
v_cos_f32 v232, v226
v_sin_f32 v233, v226
v_add_f32 v226, v226, v224
v_cos_f32 v234, v226
v_sin_f32 v235, v226
v_add_f32 v225, v225, v227
v_cvt_pk_bf16_f32 v144, v228, v229
v_cvt_pk_bf16_f32 v145, v230, v231
v_cvt_pk_bf16_f32 v146, v232, v233
v_cvt_pk_bf16_f32 v147, v234, v235
v_cos_f32 v228, v225
v_sin_f32 v229, v225
v_add_f32 v226, v225, v224
v_cos_f32 v230, v226
v_sin_f32 v231, v226
v_fma_f32 v226, 4.0, v224, v225
v_cos_f32 v232, v226
v_sin_f32 v233, v226
v_add_f32 v226, v226, v224
v_cos_f32 v234, v226
v_sin_f32 v235, v226
v_add_f32 v225, v225, v227
v_cvt_pk_bf16_f32 v148, v228, v229
v_cvt_pk_bf16_f32 v149, v230, v231
s_addk_i32 s51, 8192
s_addk_i32 m0, 1024
s_nop 0
buffer_load_dwordx4 v45, s[8:11], s51 offen lds
v_cvt_pk_bf16_f32 v150, v232, v233
v_cvt_pk_bf16_f32 v151, v234, v235
v_cos_f32 v228, v225
v_sin_f32 v229, v225
v_add_f32 v226, v225, v224
v_cos_f32 v230, v226
v_sin_f32 v231, v226
v_fma_f32 v226, 4.0, v224, v225
v_cos_f32 v232, v226
v_sin_f32 v233, v226
v_add_f32 v226, v226, v224
v_cos_f32 v234, v226
v_sin_f32 v235, v226
v_add_f32 v225, v225, v227
v_cvt_pk_bf16_f32 v152, v228, v229
v_cvt_pk_bf16_f32 v153, v230, v231
v_cvt_pk_bf16_f32 v154, v232, v233
v_cvt_pk_bf16_f32 v155, v234, v235
v_cos_f32 v228, v225
v_sin_f32 v229, v225
v_add_f32 v226, v225, v224
v_cos_f32 v230, v226
v_sin_f32 v231, v226
v_fma_f32 v226, 4.0, v224, v225
v_cos_f32 v232, v226
v_sin_f32 v233, v226
v_add_f32 v226, v226, v224
v_cos_f32 v234, v226
v_sin_f32 v235, v226
v_add_f32 v225, v225, v227
v_cvt_pk_bf16_f32 v156, v228, v229
v_cvt_pk_bf16_f32 v157, v230, v231
s_add_u32 s51, s47, 262144
s_add_u32 m0, s50, 65536
s_nop 0
buffer_load_dwordx4 v45, s[8:11], s51 offen lds
v_cvt_pk_bf16_f32 v158, v232, v233
v_cvt_pk_bf16_f32 v159, v234, v235
v_cos_f32 v228, v225
v_sin_f32 v229, v225
v_add_f32 v226, v225, v224
v_cos_f32 v230, v226
v_sin_f32 v231, v226
v_fma_f32 v226, 4.0, v224, v225
v_cos_f32 v232, v226
v_sin_f32 v233, v226
v_add_f32 v226, v226, v224
v_cos_f32 v234, v226
v_sin_f32 v235, v226
v_add_f32 v225, v225, v227
v_cvt_pk_bf16_f32 v160, v228, v229
v_cvt_pk_bf16_f32 v161, v230, v231
v_cvt_pk_bf16_f32 v162, v232, v233
v_cvt_pk_bf16_f32 v163, v234, v235
v_cos_f32 v228, v225
v_sin_f32 v229, v225
v_add_f32 v226, v225, v224
v_cos_f32 v230, v226
v_sin_f32 v231, v226
v_fma_f32 v226, 4.0, v224, v225
v_cos_f32 v232, v226
v_sin_f32 v233, v226
v_add_f32 v226, v226, v224
v_cos_f32 v234, v226
v_sin_f32 v235, v226
v_add_f32 v225, v225, v227
v_cvt_pk_bf16_f32 v164, v228, v229
v_cvt_pk_bf16_f32 v165, v230, v231
v_cvt_pk_bf16_f32 v166, v232, v233
s_addk_i32 s51, 8192
s_addk_i32 m0, 1024
s_nop 0
buffer_load_dwordx4 v45, s[8:11], s51 offen lds
v_cvt_pk_bf16_f32 v167, v234, v235
v_cos_f32 v228, v225
v_sin_f32 v229, v225
v_add_f32 v226, v225, v224
v_cos_f32 v230, v226
v_sin_f32 v231, v226
v_fma_f32 v226, 4.0, v224, v225
v_cos_f32 v232, v226
v_sin_f32 v233, v226
v_add_f32 v226, v226, v224
v_cos_f32 v234, v226
v_sin_f32 v235, v226
v_add_f32 v225, v225, v227
v_cvt_pk_bf16_f32 v168, v228, v229
v_cvt_pk_bf16_f32 v169, v230, v231
v_cvt_pk_bf16_f32 v170, v232, v233
v_cvt_pk_bf16_f32 v171, v234, v235
v_cos_f32 v228, v225
v_sin_f32 v229, v225
v_add_f32 v226, v225, v224
v_cos_f32 v230, v226
v_sin_f32 v231, v226
v_fma_f32 v226, 4.0, v224, v225
v_cos_f32 v232, v226
v_sin_f32 v233, v226
v_add_f32 v226, v226, v224
v_cos_f32 v234, v226
v_sin_f32 v235, v226
v_add_f32 v225, v225, v227
v_cvt_pk_bf16_f32 v172, v228, v229
v_cvt_pk_bf16_f32 v173, v230, v231
v_cvt_pk_bf16_f32 v174, v232, v233
s_add_u32 s51, s47, 327680
s_add_u32 m0, s50, 81920
s_nop 0
buffer_load_dwordx4 v45, s[8:11], s51 offen lds
v_cvt_pk_bf16_f32 v175, v234, v235
v_cos_f32 v228, v225
v_sin_f32 v229, v225
v_add_f32 v226, v225, v224
v_cos_f32 v230, v226
v_sin_f32 v231, v226
v_fma_f32 v226, 4.0, v224, v225
v_cos_f32 v232, v226
v_sin_f32 v233, v226
v_add_f32 v226, v226, v224
v_cos_f32 v234, v226
v_sin_f32 v235, v226
v_add_f32 v225, v225, v227
v_cvt_pk_bf16_f32 v176, v228, v229
v_cvt_pk_bf16_f32 v177, v230, v231
v_cvt_pk_bf16_f32 v178, v232, v233
v_cvt_pk_bf16_f32 v179, v234, v235
v_cos_f32 v228, v225
v_sin_f32 v229, v225
v_add_f32 v226, v225, v224
v_cos_f32 v230, v226
v_sin_f32 v231, v226
v_fma_f32 v226, 4.0, v224, v225
v_cos_f32 v232, v226
v_sin_f32 v233, v226
v_add_f32 v226, v226, v224
v_cos_f32 v234, v226
v_sin_f32 v235, v226
v_add_f32 v225, v225, v227
v_cvt_pk_bf16_f32 v180, v228, v229
v_cvt_pk_bf16_f32 v181, v230, v231
v_cvt_pk_bf16_f32 v182, v232, v233
v_cvt_pk_bf16_f32 v183, v234, v235
s_addk_i32 s51, 8192
s_addk_i32 m0, 1024
s_nop 0
buffer_load_dwordx4 v45, s[8:11], s51 offen lds
v_cos_f32 v228, v225
v_sin_f32 v229, v225
v_add_f32 v226, v225, v224
v_cos_f32 v230, v226
v_sin_f32 v231, v226
v_fma_f32 v226, 4.0, v224, v225
v_cos_f32 v232, v226
v_sin_f32 v233, v226
v_add_f32 v226, v226, v224
v_cos_f32 v234, v226
v_sin_f32 v235, v226
v_add_f32 v225, v225, v227
v_cvt_pk_bf16_f32 v184, v228, v229
v_cvt_pk_bf16_f32 v185, v230, v231
v_cvt_pk_bf16_f32 v186, v232, v233
v_cvt_pk_bf16_f32 v187, v234, v235
v_cos_f32 v228, v225
v_sin_f32 v229, v225
v_add_f32 v226, v225, v224
v_cos_f32 v230, v226
v_sin_f32 v231, v226
v_fma_f32 v226, 4.0, v224, v225
v_cos_f32 v232, v226
v_sin_f32 v233, v226
v_add_f32 v226, v226, v224
v_cos_f32 v234, v226
v_sin_f32 v235, v226
v_add_f32 v225, v225, v227
v_cvt_pk_bf16_f32 v188, v228, v229
v_cvt_pk_bf16_f32 v189, v230, v231
v_cvt_pk_bf16_f32 v190, v232, v233
v_cvt_pk_bf16_f32 v191, v234, v235
s_barrier
v_cos_f32 v228, v225
v_sin_f32 v229, v225
v_add_f32 v226, v225, v224
v_cos_f32 v230, v226
v_sin_f32 v231, v226
v_fma_f32 v226, 4.0, v224, v225
v_cos_f32 v232, v226
v_sin_f32 v233, v226
v_add_f32 v226, v226, v224
v_cos_f32 v234, v226
v_sin_f32 v235, v226
v_add_f32 v225, v225, v227
v_cvt_pk_bf16_f32 v192, v228, v229
v_cvt_pk_bf16_f32 v193, v230, v231
v_cvt_pk_bf16_f32 v194, v232, v233
v_cvt_pk_bf16_f32 v195, v234, v235
s_add_u32 s51, s48, 0
s_add_u32 m0, s50, 2048
s_nop 0
buffer_load_dwordx4 v47, s[12:15], s51 offen sc1 lds
s_add_u32 s51, s49, 0
s_addk_i32 m0, 1024
s_nop 0
buffer_load_dwordx4 v47, s[12:15], s51 offen sc1 lds
s_add_u32 s51, s48, 4096
s_add_u32 m0, s50, 18432
s_nop 0
buffer_load_dwordx4 v47, s[12:15], s51 offen sc1 lds
s_add_u32 s51, s49, 4096
s_addk_i32 m0, 1024
s_nop 0
buffer_load_dwordx4 v47, s[12:15], s51 offen sc1 lds
s_add_u32 s51, s48, 8192
s_add_u32 m0, s50, 34816
s_nop 0
buffer_load_dwordx4 v47, s[12:15], s51 offen sc1 lds
s_add_u32 s51, s49, 8192
s_addk_i32 m0, 1024
s_nop 0
buffer_load_dwordx4 v47, s[12:15], s51 offen sc1 lds
s_add_u32 s51, s48, 12288
s_add_u32 m0, s50, 51200
s_nop 0
buffer_load_dwordx4 v47, s[12:15], s51 offen sc1 lds
s_add_u32 s51, s49, 12288
s_addk_i32 m0, 1024
s_nop 0
buffer_load_dwordx4 v47, s[12:15], s51 offen sc1 lds
s_add_u32 s51, s48, 16384
s_add_u32 m0, s50, 67584
s_nop 0
buffer_load_dwordx4 v47, s[12:15], s51 offen sc1 lds
s_add_u32 s51, s49, 16384
s_addk_i32 m0, 1024
s_nop 0
buffer_load_dwordx4 v47, s[12:15], s51 offen sc1 lds
s_add_u32 s51, s48, 20480
s_add_u32 m0, s50, 83968
s_nop 0
buffer_load_dwordx4 v47, s[12:15], s51 offen sc1 lds
s_add_u32 s51, s49, 20480
s_addk_i32 m0, 1024
s_nop 0
buffer_load_dwordx4 v47, s[12:15], s51 offen sc1 lds
buffer_load_dword v44, v44, s[20:23], s55 offen sc1
buffer_load_dwordx4 v[16:19], v12, s[24:27], 0 offen
s_waitcnt vmcnt(12)
s_barrier
ds_read_b64_tr_b16 v[48:49], v40 offset:0
ds_read_b64_tr_b16 v[50:51], v40 offset:1024
ds_read_b128 v[52:55], v41 offset:0
ds_read_b64_tr_b16 v[56:57], v40 offset:4096
ds_read_b64_tr_b16 v[58:59], v40 offset:5120
ds_read_b128 v[60:63], v41 offset:4096
ds_read_b64_tr_b16 v[64:65], v40 offset:8192
ds_read_b64_tr_b16 v[66:67], v40 offset:9216
ds_read_b128 v[68:71], v41 offset:8192
ds_read_b64_tr_b16 v[72:73], v40 offset:12288
ds_read_b64_tr_b16 v[74:75], v40 offset:13312
ds_read_b128 v[76:79], v41 offset:12288
s_waitcnt vmcnt(10)
s_barrier
s_waitcnt lgkmcnt(9)
v_mfma_f32_32x32x16_bf16 v[80:95], v[48:51], v[52:55], v[80:95]
ds_read_b64_tr_b16 v[48:49], v40 offset:16384
ds_read_b64_tr_b16 v[50:51], v40 offset:17408
ds_read_b128 v[52:55], v41 offset:16384
s_add_u32 s51, s47, 393216
s_add_u32 m0, s50, 98304
s_nop 0
buffer_load_dwordx4 v45, s[8:11], s51 offen lds
s_waitcnt lgkmcnt(9)
v_mfma_f32_32x32x16_bf16 v[80:95], v[56:59], v[60:63], v[80:95]
ds_read_b64_tr_b16 v[56:57], v40 offset:20480
ds_read_b64_tr_b16 v[58:59], v40 offset:21504
ds_read_b128 v[60:63], v41 offset:20480
s_addk_i32 s51, 8192
s_addk_i32 m0, 1024
s_nop 0
buffer_load_dwordx4 v45, s[8:11], s51 offen lds
s_waitcnt lgkmcnt(9)
v_mfma_f32_32x32x16_bf16 v[80:95], v[64:67], v[68:71], v[80:95]
ds_read_b64_tr_b16 v[64:65], v40 offset:24576
ds_read_b64_tr_b16 v[66:67], v40 offset:25600
ds_read_b128 v[68:71], v41 offset:24576
s_add_u32 s51, s48, 24576
s_add_u32 m0, s50, 100352
s_nop 0
buffer_load_dwordx4 v47, s[12:15], s51 offen sc1 lds
s_waitcnt lgkmcnt(9)
v_mfma_f32_32x32x16_bf16 v[80:95], v[72:75], v[76:79], v[80:95]
ds_read_b64_tr_b16 v[72:73], v40 offset:28672
ds_read_b64_tr_b16 v[74:75], v40 offset:29696
ds_read_b128 v[76:79], v41 offset:28672
s_add_u32 s51, s49, 24576
s_addk_i32 m0, 1024
s_nop 0
buffer_load_dwordx4 v47, s[12:15], s51 offen sc1 lds
s_waitcnt vmcnt(12)
s_barrier
s_waitcnt lgkmcnt(9)
v_mfma_f32_32x32x16_bf16 v[80:95], v[48:51], v[52:55], v[80:95]
ds_read_b64_tr_b16 v[48:49], v40 offset:32768
ds_read_b64_tr_b16 v[50:51], v40 offset:33792
ds_read_b128 v[52:55], v41 offset:32768
s_add_u32 s51, s47, 458752
s_add_u32 m0, s50, 0
s_nop 0
buffer_load_dwordx4 v45, s[8:11], s51 offen lds
s_waitcnt lgkmcnt(9)
v_mfma_f32_32x32x16_bf16 v[80:95], v[56:59], v[60:63], v[80:95]
ds_read_b64_tr_b16 v[56:57], v40 offset:36864
ds_read_b64_tr_b16 v[58:59], v40 offset:37888
ds_read_b128 v[60:63], v41 offset:36864
s_addk_i32 s51, 8192
s_addk_i32 m0, 1024
s_nop 0
buffer_load_dwordx4 v45, s[8:11], s51 offen lds
s_waitcnt lgkmcnt(9)
v_mfma_f32_32x32x16_bf16 v[80:95], v[64:67], v[68:71], v[80:95]
ds_read_b64_tr_b16 v[64:65], v40 offset:40960
ds_read_b64_tr_b16 v[66:67], v40 offset:41984
ds_read_b128 v[68:71], v41 offset:40960
s_add_u32 s51, s48, 28672
s_add_u32 m0, s50, 2048
s_nop 0
buffer_load_dwordx4 v47, s[12:15], s51 offen sc1 lds
s_waitcnt lgkmcnt(9)
v_mfma_f32_32x32x16_bf16 v[80:95], v[72:75], v[76:79], v[80:95]
ds_read_b64_tr_b16 v[72:73], v40 offset:45056
ds_read_b64_tr_b16 v[74:75], v40 offset:46080
ds_read_b128 v[76:79], v41 offset:45056
s_add_u32 s51, s49, 28672
s_addk_i32 m0, 1024
s_nop 0
buffer_load_dwordx4 v47, s[12:15], s51 offen sc1 lds
s_waitcnt vmcnt(14)
s_barrier
s_waitcnt lgkmcnt(9)
v_mfma_f32_32x32x16_bf16 v[80:95], v[48:51], v[52:55], v[80:95]
ds_read_b64_tr_b16 v[48:49], v40 offset:49152
ds_read_b64_tr_b16 v[50:51], v40 offset:50176
ds_read_b128 v[52:55], v41 offset:49152
s_add_u32 s51, s47, 524288
s_add_u32 m0, s50, 16384
s_nop 0
buffer_load_dwordx4 v45, s[8:11], s51 offen lds
s_waitcnt lgkmcnt(9)
v_mfma_f32_32x32x16_bf16 v[80:95], v[56:59], v[60:63], v[80:95]
ds_read_b64_tr_b16 v[56:57], v40 offset:53248
ds_read_b64_tr_b16 v[58:59], v40 offset:54272
ds_read_b128 v[60:63], v41 offset:53248
s_addk_i32 s51, 8192
s_addk_i32 m0, 1024
s_nop 0
buffer_load_dwordx4 v45, s[8:11], s51 offen lds
s_waitcnt lgkmcnt(9)
v_mfma_f32_32x32x16_bf16 v[80:95], v[64:67], v[68:71], v[80:95]
ds_read_b64_tr_b16 v[64:65], v40 offset:57344
ds_read_b64_tr_b16 v[66:67], v40 offset:58368
ds_read_b128 v[68:71], v41 offset:57344
s_add_u32 s51, s48, 32768
s_add_u32 m0, s50, 18432
s_nop 0
buffer_load_dwordx4 v47, s[12:15], s51 offen sc1 lds
s_waitcnt lgkmcnt(9)
v_mfma_f32_32x32x16_bf16 v[80:95], v[72:75], v[76:79], v[80:95]
ds_read_b64_tr_b16 v[72:73], v40 offset:61440
ds_read_b64_tr_b16 v[74:75], v40 offset:62464
ds_read_b128 v[76:79], v41 offset:61440
s_add_u32 s51, s49, 32768
s_addk_i32 m0, 1024
s_nop 0
buffer_load_dwordx4 v47, s[12:15], s51 offen sc1 lds
s_waitcnt vmcnt(16)
s_barrier
s_waitcnt lgkmcnt(9)
v_mfma_f32_32x32x16_bf16 v[80:95], v[48:51], v[52:55], v[80:95]
ds_read_b64_tr_b16 v[48:49], v36 offset:0
ds_read_b64_tr_b16 v[50:51], v36 offset:1024
ds_read_b128 v[52:55], v37 offset:0
s_add_u32 s51, s47, 589824
s_add_u32 m0, s50, 32768
s_nop 0
buffer_load_dwordx4 v45, s[8:11], s51 offen lds
s_waitcnt lgkmcnt(9)
v_mfma_f32_32x32x16_bf16 v[80:95], v[56:59], v[60:63], v[80:95]
ds_read_b64_tr_b16 v[56:57], v36 offset:4096
ds_read_b64_tr_b16 v[58:59], v36 offset:5120
ds_read_b128 v[60:63], v37 offset:4096
s_addk_i32 s51, 8192
s_addk_i32 m0, 1024
s_nop 0
buffer_load_dwordx4 v45, s[8:11], s51 offen lds
s_waitcnt lgkmcnt(9)
v_mfma_f32_32x32x16_bf16 v[80:95], v[64:67], v[68:71], v[80:95]
ds_read_b64_tr_b16 v[64:65], v36 offset:8192
ds_read_b64_tr_b16 v[66:67], v36 offset:9216
ds_read_b128 v[68:71], v37 offset:8192
s_add_u32 s51, s48, 36864
s_add_u32 m0, s50, 34816
s_nop 0
buffer_load_dwordx4 v47, s[12:15], s51 offen sc1 lds
s_waitcnt lgkmcnt(9)
v_mfma_f32_32x32x16_bf16 v[80:95], v[72:75], v[76:79], v[80:95]
ds_read_b64_tr_b16 v[72:73], v36 offset:12288
ds_read_b64_tr_b16 v[74:75], v36 offset:13312
ds_read_b128 v[76:79], v37 offset:12288
s_add_u32 s51, s49, 36864
s_addk_i32 m0, 1024
s_nop 0
buffer_load_dwordx4 v47, s[12:15], s51 offen sc1 lds
s_waitcnt vmcnt(18)
s_barrier
s_waitcnt lgkmcnt(9)
v_mfma_f32_32x32x16_bf16 v[80:95], v[48:51], v[52:55], v[80:95]
ds_read_b64_tr_b16 v[48:49], v36 offset:16384
ds_read_b64_tr_b16 v[50:51], v36 offset:17408
ds_read_b128 v[52:55], v37 offset:16384
s_add_u32 s51, s47, 655360
s_add_u32 m0, s50, 49152
s_nop 0
buffer_load_dwordx4 v45, s[8:11], s51 offen lds
s_waitcnt lgkmcnt(9)
v_mfma_f32_32x32x16_bf16 v[80:95], v[56:59], v[60:63], v[80:95]
ds_read_b64_tr_b16 v[56:57], v36 offset:20480
ds_read_b64_tr_b16 v[58:59], v36 offset:21504
ds_read_b128 v[60:63], v37 offset:20480
s_addk_i32 s51, 8192
s_addk_i32 m0, 1024
s_nop 0
buffer_load_dwordx4 v45, s[8:11], s51 offen lds
s_waitcnt lgkmcnt(9)
v_mfma_f32_32x32x16_bf16 v[80:95], v[64:67], v[68:71], v[80:95]
ds_read_b64_tr_b16 v[64:65], v36 offset:24576
ds_read_b64_tr_b16 v[66:67], v36 offset:25600
ds_read_b128 v[68:71], v37 offset:24576
s_add_u32 s51, s48, 40960
s_add_u32 m0, s50, 51200
s_nop 0
buffer_load_dwordx4 v47, s[12:15], s51 offen sc1 lds
s_waitcnt lgkmcnt(9)
v_mfma_f32_32x32x16_bf16 v[80:95], v[72:75], v[76:79], v[80:95]
ds_read_b64_tr_b16 v[72:73], v36 offset:28672
ds_read_b64_tr_b16 v[74:75], v36 offset:29696
ds_read_b128 v[76:79], v37 offset:28672
s_add_u32 s51, s49, 40960
s_addk_i32 m0, 1024
s_nop 0
buffer_load_dwordx4 v47, s[12:15], s51 offen sc1 lds
s_waitcnt vmcnt(16)
s_barrier
s_waitcnt lgkmcnt(9)
v_mfma_f32_32x32x16_bf16 v[80:95], v[48:51], v[52:55], v[80:95]
ds_read_b64_tr_b16 v[48:49], v36 offset:32768
ds_read_b64_tr_b16 v[50:51], v36 offset:33792
ds_read_b128 v[52:55], v37 offset:32768
s_add_u32 s51, s47, 720896
s_add_u32 m0, s50, 65536
s_nop 0
buffer_load_dwordx4 v45, s[8:11], s51 offen lds
s_waitcnt lgkmcnt(9)
v_mfma_f32_32x32x16_bf16 v[80:95], v[56:59], v[60:63], v[80:95]
ds_read_b64_tr_b16 v[56:57], v36 offset:36864
ds_read_b64_tr_b16 v[58:59], v36 offset:37888
ds_read_b128 v[60:63], v37 offset:36864
s_addk_i32 s51, 8192
s_addk_i32 m0, 1024
s_nop 0
buffer_load_dwordx4 v45, s[8:11], s51 offen lds
s_waitcnt lgkmcnt(9)
v_mfma_f32_32x32x16_bf16 v[80:95], v[64:67], v[68:71], v[80:95]
ds_read_b64_tr_b16 v[64:65], v36 offset:40960
ds_read_b64_tr_b16 v[66:67], v36 offset:41984
ds_read_b128 v[68:71], v37 offset:40960
s_add_u32 s51, s48, 45056
s_add_u32 m0, s50, 67584
s_nop 0
buffer_load_dwordx4 v47, s[12:15], s51 offen sc1 lds
s_waitcnt lgkmcnt(9)
v_mfma_f32_32x32x16_bf16 v[80:95], v[72:75], v[76:79], v[80:95]
ds_read_b64_tr_b16 v[72:73], v36 offset:45056
ds_read_b64_tr_b16 v[74:75], v36 offset:46080
ds_read_b128 v[76:79], v37 offset:45056
s_add_u32 s51, s49, 45056
s_addk_i32 m0, 1024
s_nop 0
buffer_load_dwordx4 v47, s[12:15], s51 offen sc1 lds
s_waitcnt vmcnt(16)
s_barrier
s_waitcnt lgkmcnt(9)
v_mfma_f32_32x32x16_bf16 v[80:95], v[48:51], v[52:55], v[80:95]
ds_read_b64_tr_b16 v[48:49], v40 offset:0
ds_read_b64_tr_b16 v[50:51], v40 offset:1024
ds_read_b128 v[52:55], v41 offset:0
s_add_u32 s51, s47, 786432
s_add_u32 m0, s50, 81920
s_nop 0
buffer_load_dwordx4 v45, s[8:11], s51 offen lds
s_waitcnt lgkmcnt(9)
v_mfma_f32_32x32x16_bf16 v[80:95], v[56:59], v[60:63], v[80:95]
ds_read_b64_tr_b16 v[56:57], v40 offset:4096
ds_read_b64_tr_b16 v[58:59], v40 offset:5120
ds_read_b128 v[60:63], v41 offset:4096
s_addk_i32 s51, 8192
s_addk_i32 m0, 1024
s_nop 0
buffer_load_dwordx4 v45, s[8:11], s51 offen lds
s_waitcnt lgkmcnt(9)
v_mfma_f32_32x32x16_bf16 v[80:95], v[64:67], v[68:71], v[80:95]
ds_read_b64_tr_b16 v[64:65], v40 offset:8192
ds_read_b64_tr_b16 v[66:67], v40 offset:9216
ds_read_b128 v[68:71], v41 offset:8192
s_add_u32 s51, s48, 49152
s_add_u32 m0, s50, 83968
s_nop 0
buffer_load_dwordx4 v47, s[12:15], s51 offen sc1 lds
s_waitcnt lgkmcnt(9)
v_mfma_f32_32x32x16_bf16 v[80:95], v[72:75], v[76:79], v[80:95]
ds_read_b64_tr_b16 v[72:73], v40 offset:12288
ds_read_b64_tr_b16 v[74:75], v40 offset:13312
ds_read_b128 v[76:79], v41 offset:12288
s_add_u32 s51, s49, 49152
s_addk_i32 m0, 1024
s_nop 0
buffer_load_dwordx4 v47, s[12:15], s51 offen sc1 lds
s_waitcnt vmcnt(16)
s_barrier
s_waitcnt lgkmcnt(9)
v_mfma_f32_32x32x16_bf16 v[80:95], v[48:51], v[52:55], v[80:95]
ds_read_b64_tr_b16 v[48:49], v40 offset:16384
ds_read_b64_tr_b16 v[50:51], v40 offset:17408
ds_read_b128 v[52:55], v41 offset:16384
s_add_u32 s51, s47, 851968
s_add_u32 m0, s50, 98304
s_nop 0
buffer_load_dwordx4 v45, s[8:11], s51 offen lds
s_waitcnt lgkmcnt(9)
v_mfma_f32_32x32x16_bf16 v[80:95], v[56:59], v[60:63], v[80:95]
ds_read_b64_tr_b16 v[56:57], v40 offset:20480
ds_read_b64_tr_b16 v[58:59], v40 offset:21504
ds_read_b128 v[60:63], v41 offset:20480
s_addk_i32 s51, 8192
s_addk_i32 m0, 1024
s_nop 0
buffer_load_dwordx4 v45, s[8:11], s51 offen lds
s_waitcnt lgkmcnt(9)
v_mfma_f32_32x32x16_bf16 v[80:95], v[64:67], v[68:71], v[80:95]
ds_read_b64_tr_b16 v[64:65], v40 offset:24576
ds_read_b64_tr_b16 v[66:67], v40 offset:25600
ds_read_b128 v[68:71], v41 offset:24576
s_add_u32 s51, s48, 53248
s_add_u32 m0, s50, 100352
s_nop 0
buffer_load_dwordx4 v47, s[12:15], s51 offen sc1 lds
s_waitcnt lgkmcnt(9)
v_mfma_f32_32x32x16_bf16 v[80:95], v[72:75], v[76:79], v[80:95]
ds_read_b64_tr_b16 v[72:73], v40 offset:28672
ds_read_b64_tr_b16 v[74:75], v40 offset:29696
ds_read_b128 v[76:79], v41 offset:28672
s_add_u32 s51, s49, 53248
s_addk_i32 m0, 1024
s_nop 0
buffer_load_dwordx4 v47, s[12:15], s51 offen sc1 lds
s_waitcnt vmcnt(16)
s_barrier
s_waitcnt lgkmcnt(9)
v_mfma_f32_32x32x16_bf16 v[80:95], v[48:51], v[52:55], v[80:95]
ds_read_b64_tr_b16 v[48:49], v40 offset:32768
ds_read_b64_tr_b16 v[50:51], v40 offset:33792
ds_read_b128 v[52:55], v41 offset:32768
s_add_u32 s51, s47, 917504
s_add_u32 m0, s50, 0
s_nop 0
buffer_load_dwordx4 v45, s[8:11], s51 offen lds
s_waitcnt lgkmcnt(9)
v_mfma_f32_32x32x16_bf16 v[80:95], v[56:59], v[60:63], v[80:95]
ds_read_b64_tr_b16 v[56:57], v40 offset:36864
ds_read_b64_tr_b16 v[58:59], v40 offset:37888
ds_read_b128 v[60:63], v41 offset:36864
s_addk_i32 s51, 8192
s_addk_i32 m0, 1024
s_nop 0
buffer_load_dwordx4 v45, s[8:11], s51 offen lds
s_waitcnt lgkmcnt(9)
v_mfma_f32_32x32x16_bf16 v[80:95], v[64:67], v[68:71], v[80:95]
ds_read_b64_tr_b16 v[64:65], v40 offset:40960
ds_read_b64_tr_b16 v[66:67], v40 offset:41984
ds_read_b128 v[68:71], v41 offset:40960
s_add_u32 s51, s48, 57344
s_add_u32 m0, s50, 2048
s_nop 0
buffer_load_dwordx4 v47, s[12:15], s51 offen sc1 lds
s_waitcnt lgkmcnt(9)
v_mfma_f32_32x32x16_bf16 v[80:95], v[72:75], v[76:79], v[80:95]
ds_read_b64_tr_b16 v[72:73], v40 offset:45056
ds_read_b64_tr_b16 v[74:75], v40 offset:46080
ds_read_b128 v[76:79], v41 offset:45056
s_add_u32 s51, s49, 57344
s_addk_i32 m0, 1024
s_nop 0
buffer_load_dwordx4 v47, s[12:15], s51 offen sc1 lds
s_waitcnt vmcnt(16)
s_barrier
s_waitcnt lgkmcnt(9)
v_mfma_f32_32x32x16_bf16 v[80:95], v[48:51], v[52:55], v[80:95]
ds_read_b64_tr_b16 v[48:49], v40 offset:49152
ds_read_b64_tr_b16 v[50:51], v40 offset:50176
ds_read_b128 v[52:55], v41 offset:49152
s_add_u32 s51, s47, 983040
s_add_u32 m0, s50, 16384
s_nop 0
buffer_load_dwordx4 v45, s[8:11], s51 offen lds
s_waitcnt lgkmcnt(9)
v_mfma_f32_32x32x16_bf16 v[80:95], v[56:59], v[60:63], v[80:95]
ds_read_b64_tr_b16 v[56:57], v40 offset:53248
ds_read_b64_tr_b16 v[58:59], v40 offset:54272
ds_read_b128 v[60:63], v41 offset:53248
s_addk_i32 s51, 8192
s_addk_i32 m0, 1024
s_nop 0
buffer_load_dwordx4 v45, s[8:11], s51 offen lds
s_waitcnt lgkmcnt(9)
v_mfma_f32_32x32x16_bf16 v[80:95], v[64:67], v[68:71], v[80:95]
ds_read_b64_tr_b16 v[64:65], v40 offset:57344
ds_read_b64_tr_b16 v[66:67], v40 offset:58368
ds_read_b128 v[68:71], v41 offset:57344
s_add_u32 s51, s48, 61440
s_add_u32 m0, s50, 18432
s_nop 0
buffer_load_dwordx4 v47, s[12:15], s51 offen sc1 lds
s_waitcnt lgkmcnt(9)
v_mfma_f32_32x32x16_bf16 v[80:95], v[72:75], v[76:79], v[80:95]
ds_read_b64_tr_b16 v[72:73], v40 offset:61440
ds_read_b64_tr_b16 v[74:75], v40 offset:62464
ds_read_b128 v[76:79], v41 offset:61440
s_add_u32 s51, s49, 61440
s_addk_i32 m0, 1024
s_nop 0
buffer_load_dwordx4 v47, s[12:15], s51 offen sc1 lds
s_waitcnt vmcnt(16)
s_barrier
s_waitcnt lgkmcnt(9)
v_mfma_f32_32x32x16_bf16 v[80:95], v[48:51], v[52:55], v[80:95]
ds_read_b64_tr_b16 v[48:49], v36 offset:0
ds_read_b64_tr_b16 v[50:51], v36 offset:1024
ds_read_b128 v[52:55], v37 offset:0
s_add_u32 s51, s47, 1048576
s_add_u32 m0, s50, 32768
s_nop 0
buffer_load_dwordx4 v45, s[8:11], s51 offen lds
s_waitcnt lgkmcnt(9)
v_mfma_f32_32x32x16_bf16 v[80:95], v[56:59], v[60:63], v[80:95]
ds_read_b64_tr_b16 v[56:57], v36 offset:4096
ds_read_b64_tr_b16 v[58:59], v36 offset:5120
ds_read_b128 v[60:63], v37 offset:4096
s_addk_i32 s51, 8192
s_addk_i32 m0, 1024
s_nop 0
buffer_load_dwordx4 v45, s[8:11], s51 offen lds
s_waitcnt lgkmcnt(9)
v_mfma_f32_32x32x16_bf16 v[80:95], v[64:67], v[68:71], v[80:95]
ds_read_b64_tr_b16 v[64:65], v36 offset:8192
ds_read_b64_tr_b16 v[66:67], v36 offset:9216
ds_read_b128 v[68:71], v37 offset:8192
s_add_u32 s51, s48, 65536
s_add_u32 m0, s50, 34816
s_nop 0
buffer_load_dwordx4 v47, s[12:15], s51 offen sc1 lds
s_waitcnt lgkmcnt(9)
v_mfma_f32_32x32x16_bf16 v[80:95], v[72:75], v[76:79], v[80:95]
ds_read_b64_tr_b16 v[72:73], v36 offset:12288
ds_read_b64_tr_b16 v[74:75], v36 offset:13312
ds_read_b128 v[76:79], v37 offset:12288
s_add_u32 s51, s49, 65536
s_addk_i32 m0, 1024
s_nop 0
buffer_load_dwordx4 v47, s[12:15], s51 offen sc1 lds
s_waitcnt vmcnt(16)
s_barrier
s_waitcnt lgkmcnt(9)
v_mfma_f32_32x32x16_bf16 v[80:95], v[48:51], v[52:55], v[80:95]
ds_read_b64_tr_b16 v[48:49], v36 offset:16384
ds_read_b64_tr_b16 v[50:51], v36 offset:17408
ds_read_b128 v[52:55], v37 offset:16384
s_add_u32 s51, s47, 1114112
s_add_u32 m0, s50, 49152
s_nop 0
buffer_load_dwordx4 v45, s[8:11], s51 offen lds
s_waitcnt lgkmcnt(9)
v_mfma_f32_32x32x16_bf16 v[80:95], v[56:59], v[60:63], v[80:95]
ds_read_b64_tr_b16 v[56:57], v36 offset:20480
ds_read_b64_tr_b16 v[58:59], v36 offset:21504
ds_read_b128 v[60:63], v37 offset:20480
s_addk_i32 s51, 8192
s_addk_i32 m0, 1024
s_nop 0
buffer_load_dwordx4 v45, s[8:11], s51 offen lds
s_waitcnt lgkmcnt(9)
v_mfma_f32_32x32x16_bf16 v[80:95], v[64:67], v[68:71], v[80:95]
ds_read_b64_tr_b16 v[64:65], v36 offset:24576
ds_read_b64_tr_b16 v[66:67], v36 offset:25600
ds_read_b128 v[68:71], v37 offset:24576
s_add_u32 s51, s48, 69632
s_add_u32 m0, s50, 51200
s_nop 0
buffer_load_dwordx4 v47, s[12:15], s51 offen sc1 lds
s_waitcnt lgkmcnt(9)
v_mfma_f32_32x32x16_bf16 v[80:95], v[72:75], v[76:79], v[80:95]
ds_read_b64_tr_b16 v[72:73], v36 offset:28672
ds_read_b64_tr_b16 v[74:75], v36 offset:29696
ds_read_b128 v[76:79], v37 offset:28672
s_add_u32 s51, s49, 69632
s_addk_i32 m0, 1024
s_nop 0
buffer_load_dwordx4 v47, s[12:15], s51 offen sc1 lds
s_waitcnt vmcnt(16)
s_barrier
s_waitcnt lgkmcnt(9)
v_mfma_f32_32x32x16_bf16 v[80:95], v[48:51], v[52:55], v[80:95]
ds_read_b64_tr_b16 v[48:49], v36 offset:32768
ds_read_b64_tr_b16 v[50:51], v36 offset:33792
ds_read_b128 v[52:55], v37 offset:32768
s_add_u32 s51, s47, 1179648
s_add_u32 m0, s50, 65536
s_nop 0
buffer_load_dwordx4 v45, s[8:11], s51 offen lds
s_waitcnt lgkmcnt(9)
v_mfma_f32_32x32x16_bf16 v[80:95], v[56:59], v[60:63], v[80:95]
ds_read_b64_tr_b16 v[56:57], v36 offset:36864
ds_read_b64_tr_b16 v[58:59], v36 offset:37888
ds_read_b128 v[60:63], v37 offset:36864
s_addk_i32 s51, 8192
s_addk_i32 m0, 1024
s_nop 0
buffer_load_dwordx4 v45, s[8:11], s51 offen lds
s_waitcnt lgkmcnt(9)
v_mfma_f32_32x32x16_bf16 v[80:95], v[64:67], v[68:71], v[80:95]
ds_read_b64_tr_b16 v[64:65], v36 offset:40960
ds_read_b64_tr_b16 v[66:67], v36 offset:41984
ds_read_b128 v[68:71], v37 offset:40960
s_add_u32 s51, s48, 73728
s_add_u32 m0, s50, 67584
s_nop 0
buffer_load_dwordx4 v47, s[12:15], s51 offen sc1 lds
s_waitcnt lgkmcnt(9)
v_mfma_f32_32x32x16_bf16 v[80:95], v[72:75], v[76:79], v[80:95]
ds_read_b64_tr_b16 v[72:73], v36 offset:45056
ds_read_b64_tr_b16 v[74:75], v36 offset:46080
ds_read_b128 v[76:79], v37 offset:45056
s_add_u32 s51, s49, 73728
s_addk_i32 m0, 1024
s_nop 0
buffer_load_dwordx4 v47, s[12:15], s51 offen sc1 lds
s_waitcnt vmcnt(16)
s_barrier
s_waitcnt lgkmcnt(9)
v_mfma_f32_32x32x16_bf16 v[80:95], v[48:51], v[52:55], v[80:95]
ds_read_b64_tr_b16 v[48:49], v40 offset:0
ds_read_b64_tr_b16 v[50:51], v40 offset:1024
ds_read_b128 v[52:55], v41 offset:0
s_add_u32 s51, s47, 1245184
s_add_u32 m0, s50, 81920
s_nop 0
buffer_load_dwordx4 v45, s[8:11], s51 offen lds
s_waitcnt lgkmcnt(9)
v_mfma_f32_32x32x16_bf16 v[80:95], v[56:59], v[60:63], v[80:95]
ds_read_b64_tr_b16 v[56:57], v40 offset:4096
ds_read_b64_tr_b16 v[58:59], v40 offset:5120
ds_read_b128 v[60:63], v41 offset:4096
s_addk_i32 s51, 8192
s_addk_i32 m0, 1024
s_nop 0
buffer_load_dwordx4 v45, s[8:11], s51 offen lds
s_waitcnt lgkmcnt(9)
v_mfma_f32_32x32x16_bf16 v[80:95], v[64:67], v[68:71], v[80:95]
ds_read_b64_tr_b16 v[64:65], v40 offset:8192
ds_read_b64_tr_b16 v[66:67], v40 offset:9216
ds_read_b128 v[68:71], v41 offset:8192
s_add_u32 s51, s48, 77824
s_add_u32 m0, s50, 83968
s_nop 0
buffer_load_dwordx4 v47, s[12:15], s51 offen sc1 lds
s_waitcnt lgkmcnt(9)
v_mfma_f32_32x32x16_bf16 v[80:95], v[72:75], v[76:79], v[80:95]
ds_read_b64_tr_b16 v[72:73], v40 offset:12288
ds_read_b64_tr_b16 v[74:75], v40 offset:13312
ds_read_b128 v[76:79], v41 offset:12288
s_add_u32 s51, s49, 77824
s_addk_i32 m0, 1024
s_nop 0
buffer_load_dwordx4 v47, s[12:15], s51 offen sc1 lds
s_waitcnt vmcnt(16)
s_barrier
s_waitcnt lgkmcnt(9)
v_mfma_f32_32x32x16_bf16 v[80:95], v[48:51], v[52:55], v[80:95]
ds_read_b64_tr_b16 v[48:49], v40 offset:16384
ds_read_b64_tr_b16 v[50:51], v40 offset:17408
ds_read_b128 v[52:55], v41 offset:16384
s_add_u32 s51, s47, 1310720
s_add_u32 m0, s50, 98304
s_nop 0
buffer_load_dwordx4 v45, s[8:11], s51 offen lds
s_waitcnt lgkmcnt(9)
v_mfma_f32_32x32x16_bf16 v[80:95], v[56:59], v[60:63], v[80:95]
ds_read_b64_tr_b16 v[56:57], v40 offset:20480
ds_read_b64_tr_b16 v[58:59], v40 offset:21504
ds_read_b128 v[60:63], v41 offset:20480
s_addk_i32 s51, 8192
s_addk_i32 m0, 1024
s_nop 0
buffer_load_dwordx4 v45, s[8:11], s51 offen lds
s_waitcnt lgkmcnt(9)
v_mfma_f32_32x32x16_bf16 v[80:95], v[64:67], v[68:71], v[80:95]
ds_read_b64_tr_b16 v[64:65], v40 offset:24576
ds_read_b64_tr_b16 v[66:67], v40 offset:25600
ds_read_b128 v[68:71], v41 offset:24576
s_add_u32 s51, s48, 81920
s_add_u32 m0, s50, 100352
s_nop 0
buffer_load_dwordx4 v47, s[12:15], s51 offen sc1 lds
s_waitcnt lgkmcnt(9)
v_mfma_f32_32x32x16_bf16 v[80:95], v[72:75], v[76:79], v[80:95]
ds_read_b64_tr_b16 v[72:73], v40 offset:28672
ds_read_b64_tr_b16 v[74:75], v40 offset:29696
ds_read_b128 v[76:79], v41 offset:28672
s_add_u32 s51, s49, 81920
s_addk_i32 m0, 1024
s_nop 0
buffer_load_dwordx4 v47, s[12:15], s51 offen sc1 lds
s_waitcnt vmcnt(16)
s_barrier
s_waitcnt lgkmcnt(9)
v_mfma_f32_32x32x16_bf16 v[80:95], v[48:51], v[52:55], v[80:95]
ds_read_b64_tr_b16 v[48:49], v40 offset:32768
ds_read_b64_tr_b16 v[50:51], v40 offset:33792
ds_read_b128 v[52:55], v41 offset:32768
s_add_u32 s51, s47, 1376256
s_add_u32 m0, s50, 0
s_nop 0
buffer_load_dwordx4 v45, s[8:11], s51 offen lds
s_waitcnt lgkmcnt(9)
v_mfma_f32_32x32x16_bf16 v[80:95], v[56:59], v[60:63], v[80:95]
ds_read_b64_tr_b16 v[56:57], v40 offset:36864
ds_read_b64_tr_b16 v[58:59], v40 offset:37888
ds_read_b128 v[60:63], v41 offset:36864
s_addk_i32 s51, 8192
s_addk_i32 m0, 1024
s_nop 0
buffer_load_dwordx4 v45, s[8:11], s51 offen lds
s_waitcnt lgkmcnt(9)
v_mfma_f32_32x32x16_bf16 v[80:95], v[64:67], v[68:71], v[80:95]
ds_read_b64_tr_b16 v[64:65], v40 offset:40960
ds_read_b64_tr_b16 v[66:67], v40 offset:41984
ds_read_b128 v[68:71], v41 offset:40960
s_add_u32 s51, s48, 86016
s_cmp_ge_u32 s40, 2
s_cselect_b32 s51, 2147418112, s51
s_add_u32 m0, s50, 2048
s_nop 0
buffer_load_dwordx4 v47, s[12:15], s51 offen sc1 lds
s_waitcnt lgkmcnt(9)
v_mfma_f32_32x32x16_bf16 v[80:95], v[72:75], v[76:79], v[80:95]
ds_read_b64_tr_b16 v[72:73], v40 offset:45056
ds_read_b64_tr_b16 v[74:75], v40 offset:46080
ds_read_b128 v[76:79], v41 offset:45056
s_add_u32 s51, s49, 86016
s_cmp_ge_u32 s40, 2
s_cselect_b32 s51, 2147418112, s51
s_addk_i32 m0, 1024
s_nop 0
buffer_load_dwordx4 v47, s[12:15], s51 offen sc1 lds
s_waitcnt vmcnt(16)
s_barrier
s_waitcnt lgkmcnt(9)
v_mfma_f32_32x32x16_bf16 v[80:95], v[48:51], v[52:55], v[80:95]
ds_read_b64_tr_b16 v[48:49], v40 offset:49152
ds_read_b64_tr_b16 v[50:51], v40 offset:50176
ds_read_b128 v[52:55], v41 offset:49152
v_cos_f32 v228, v225
v_sin_f32 v229, v225
v_add_f32 v226, v225, v224
v_cos_f32 v230, v226
v_sin_f32 v231, v226
v_fma_f32 v226, 4.0, v224, v225
v_cos_f32 v232, v226
v_sin_f32 v233, v226
s_waitcnt lgkmcnt(9)
v_mfma_f32_32x32x16_bf16 v[80:95], v[56:59], v[60:63], v[80:95]
ds_read_b64_tr_b16 v[56:57], v40 offset:53248
ds_read_b64_tr_b16 v[58:59], v40 offset:54272
ds_read_b128 v[60:63], v41 offset:53248
v_add_f32 v226, v226, v224
v_cos_f32 v234, v226
v_sin_f32 v235, v226
v_add_f32 v225, v225, v227
v_cvt_pk_bf16_f32 v196, v228, v229
v_cvt_pk_bf16_f32 v197, v230, v231
v_cvt_pk_bf16_f32 v198, v232, v233
v_cvt_pk_bf16_f32 v199, v234, v235
s_waitcnt lgkmcnt(9)
v_mfma_f32_32x32x16_bf16 v[80:95], v[64:67], v[68:71], v[80:95]
ds_read_b64_tr_b16 v[64:65], v40 offset:57344
ds_read_b64_tr_b16 v[66:67], v40 offset:58368
ds_read_b128 v[68:71], v41 offset:57344
v_cos_f32 v228, v225
v_sin_f32 v229, v225
v_add_f32 v226, v225, v224
v_cos_f32 v230, v226
v_sin_f32 v231, v226
v_fma_f32 v226, 4.0, v224, v225
v_cos_f32 v232, v226
v_sin_f32 v233, v226
s_waitcnt lgkmcnt(9)
v_mfma_f32_32x32x16_bf16 v[80:95], v[72:75], v[76:79], v[80:95]
ds_read_b64_tr_b16 v[72:73], v40 offset:61440
ds_read_b64_tr_b16 v[74:75], v40 offset:62464
ds_read_b128 v[76:79], v41 offset:61440
v_add_f32 v226, v226, v224
v_cos_f32 v234, v226
v_sin_f32 v235, v226
v_add_f32 v225, v225, v227
v_cvt_pk_bf16_f32 v200, v228, v229
v_cvt_pk_bf16_f32 v201, v230, v231
v_cvt_pk_bf16_f32 v202, v232, v233
v_cvt_pk_bf16_f32 v203, v234, v235
s_waitcnt vmcnt(12)
s_barrier
s_waitcnt lgkmcnt(9)
v_mfma_f32_32x32x16_bf16 v[80:95], v[48:51], v[52:55], v[80:95]
ds_read_b64_tr_b16 v[48:49], v36 offset:0
ds_read_b64_tr_b16 v[50:51], v36 offset:1024
ds_read_b128 v[52:55], v37 offset:0
v_cos_f32 v228, v225
v_sin_f32 v229, v225
v_add_f32 v226, v225, v224
v_cos_f32 v230, v226
v_sin_f32 v231, v226
v_fma_f32 v226, 4.0, v224, v225
v_cos_f32 v232, v226
v_sin_f32 v233, v226
s_waitcnt lgkmcnt(9)
v_mfma_f32_32x32x16_bf16 v[80:95], v[56:59], v[60:63], v[80:95]
ds_read_b64_tr_b16 v[56:57], v36 offset:4096
ds_read_b64_tr_b16 v[58:59], v36 offset:5120
ds_read_b128 v[60:63], v37 offset:4096
v_add_f32 v226, v226, v224
v_cos_f32 v234, v226
v_sin_f32 v235, v226
v_add_f32 v225, v225, v227
v_cvt_pk_bf16_f32 v204, v228, v229
v_cvt_pk_bf16_f32 v205, v230, v231
v_cvt_pk_bf16_f32 v206, v232, v233
v_cvt_pk_bf16_f32 v207, v234, v235
s_waitcnt lgkmcnt(9)
v_mfma_f32_32x32x16_bf16 v[80:95], v[64:67], v[68:71], v[80:95]
ds_read_b64_tr_b16 v[64:65], v36 offset:8192
ds_read_b64_tr_b16 v[66:67], v36 offset:9216
ds_read_b128 v[68:71], v37 offset:8192
v_cos_f32 v228, v225
v_sin_f32 v229, v225
v_add_f32 v226, v225, v224
v_cos_f32 v230, v226
v_sin_f32 v231, v226
v_fma_f32 v226, 4.0, v224, v225
v_cos_f32 v232, v226
v_sin_f32 v233, v226
s_waitcnt lgkmcnt(9)
v_mfma_f32_32x32x16_bf16 v[80:95], v[72:75], v[76:79], v[80:95]
ds_read_b64_tr_b16 v[72:73], v36 offset:12288
ds_read_b64_tr_b16 v[74:75], v36 offset:13312
ds_read_b128 v[76:79], v37 offset:12288
v_add_f32 v226, v226, v224
v_cos_f32 v234, v226
v_sin_f32 v235, v226
v_add_f32 v225, v225, v227
v_cvt_pk_bf16_f32 v208, v228, v229
v_cvt_pk_bf16_f32 v209, v230, v231
v_cvt_pk_bf16_f32 v210, v232, v233
v_cvt_pk_bf16_f32 v211, v234, v235
s_waitcnt vmcnt(8)
s_barrier
s_waitcnt lgkmcnt(9)
v_mfma_f32_32x32x16_bf16 v[80:95], v[48:51], v[52:55], v[80:95]
ds_read_b64_tr_b16 v[48:49], v36 offset:16384
ds_read_b64_tr_b16 v[50:51], v36 offset:17408
ds_read_b128 v[52:55], v37 offset:16384
v_cos_f32 v228, v225
v_sin_f32 v229, v225
v_add_f32 v226, v225, v224
v_cos_f32 v230, v226
v_sin_f32 v231, v226
v_fma_f32 v226, 4.0, v224, v225
v_cos_f32 v232, v226
v_sin_f32 v233, v226
s_waitcnt lgkmcnt(9)
v_mfma_f32_32x32x16_bf16 v[80:95], v[56:59], v[60:63], v[80:95]
ds_read_b64_tr_b16 v[56:57], v36 offset:20480
ds_read_b64_tr_b16 v[58:59], v36 offset:21504
ds_read_b128 v[60:63], v37 offset:20480
v_add_f32 v226, v226, v224
v_cos_f32 v234, v226
v_sin_f32 v235, v226
v_add_f32 v225, v225, v227
v_cvt_pk_bf16_f32 v212, v228, v229
v_cvt_pk_bf16_f32 v213, v230, v231
v_cvt_pk_bf16_f32 v214, v232, v233
v_cvt_pk_bf16_f32 v215, v234, v235
s_waitcnt lgkmcnt(9)
v_mfma_f32_32x32x16_bf16 v[80:95], v[64:67], v[68:71], v[80:95]
ds_read_b64_tr_b16 v[64:65], v36 offset:24576
ds_read_b64_tr_b16 v[66:67], v36 offset:25600
ds_read_b128 v[68:71], v37 offset:24576
v_cos_f32 v228, v225
v_sin_f32 v229, v225
v_add_f32 v226, v225, v224
v_cos_f32 v230, v226
v_sin_f32 v231, v226
v_fma_f32 v226, 4.0, v224, v225
v_cos_f32 v232, v226
v_sin_f32 v233, v226
s_waitcnt lgkmcnt(9)
v_mfma_f32_32x32x16_bf16 v[80:95], v[72:75], v[76:79], v[80:95]
ds_read_b64_tr_b16 v[72:73], v36 offset:28672
ds_read_b64_tr_b16 v[74:75], v36 offset:29696
ds_read_b128 v[76:79], v37 offset:28672
v_add_f32 v226, v226, v224
v_cos_f32 v234, v226
v_sin_f32 v235, v226
v_add_f32 v225, v225, v227
v_cvt_pk_bf16_f32 v216, v228, v229
v_cvt_pk_bf16_f32 v217, v230, v231
v_cvt_pk_bf16_f32 v218, v232, v233
v_cvt_pk_bf16_f32 v219, v234, v235
s_waitcnt vmcnt(4)
s_barrier
s_waitcnt lgkmcnt(9)
v_mfma_f32_32x32x16_bf16 v[80:95], v[48:51], v[52:55], v[80:95]
ds_read_b64_tr_b16 v[48:49], v36 offset:32768
ds_read_b64_tr_b16 v[50:51], v36 offset:33792
ds_read_b128 v[52:55], v37 offset:32768
v_cos_f32 v228, v225
v_sin_f32 v229, v225
v_add_f32 v226, v225, v224
v_cos_f32 v230, v226
s_waitcnt lgkmcnt(9)
v_mfma_f32_32x32x16_bf16 v[80:95], v[56:59], v[60:63], v[80:95]
ds_read_b64_tr_b16 v[56:57], v36 offset:36864
ds_read_b64_tr_b16 v[58:59], v36 offset:37888
ds_read_b128 v[60:63], v37 offset:36864
v_sin_f32 v231, v226
v_fma_f32 v226, 4.0, v224, v225
v_cos_f32 v232, v226
v_sin_f32 v233, v226
s_waitcnt lgkmcnt(9)
v_mfma_f32_32x32x16_bf16 v[80:95], v[64:67], v[68:71], v[80:95]
ds_read_b64_tr_b16 v[64:65], v36 offset:40960
ds_read_b64_tr_b16 v[66:67], v36 offset:41984
ds_read_b128 v[68:71], v37 offset:40960
v_add_f32 v226, v226, v224
v_cos_f32 v234, v226
v_sin_f32 v235, v226
v_add_f32 v225, v225, v227
s_waitcnt lgkmcnt(9)
v_mfma_f32_32x32x16_bf16 v[80:95], v[72:75], v[76:79], v[80:95]
ds_read_b64_tr_b16 v[72:73], v36 offset:45056
ds_read_b64_tr_b16 v[74:75], v36 offset:46080
ds_read_b128 v[76:79], v37 offset:45056
v_cvt_pk_bf16_f32 v220, v228, v229
v_cvt_pk_bf16_f32 v221, v230, v231
v_cvt_pk_bf16_f32 v222, v232, v233
v_cvt_pk_bf16_f32 v223, v234, v235
s_waitcnt vmcnt(0)
s_barrier
s_waitcnt lgkmcnt(9)
v_mfma_f32_32x32x16_bf16 v[80:95], v[48:51], v[52:55], v[80:95]
ds_read_b64_tr_b16 v[48:49], v40 offset:0
ds_read_b64_tr_b16 v[50:51], v40 offset:1024
ds_read_b128 v[52:55], v41 offset:0
s_waitcnt lgkmcnt(9)
v_mfma_f32_32x32x16_bf16 v[80:95], v[56:59], v[60:63], v[80:95]
ds_read_b64_tr_b16 v[56:57], v40 offset:4096
ds_read_b64_tr_b16 v[58:59], v40 offset:5120
ds_read_b128 v[60:63], v41 offset:4096
s_waitcnt lgkmcnt(9)
v_mfma_f32_32x32x16_bf16 v[80:95], v[64:67], v[68:71], v[80:95]
ds_read_b64_tr_b16 v[64:65], v40 offset:8192
ds_read_b64_tr_b16 v[66:67], v40 offset:9216
ds_read_b128 v[68:71], v41 offset:8192
s_waitcnt lgkmcnt(9)
v_mfma_f32_32x32x16_bf16 v[80:95], v[72:75], v[76:79], v[80:95]
ds_read_b64_tr_b16 v[72:73], v40 offset:12288
ds_read_b64_tr_b16 v[74:75], v40 offset:13312
ds_read_b128 v[76:79], v41 offset:12288
v_mul_f32 v44, v44, v44
s_barrier
s_waitcnt lgkmcnt(9)
v_mfma_f32_32x32x16_bf16 v[80:95], v[48:51], v[52:55], v[80:95]
ds_read_b64_tr_b16 v[48:49], v42 offset:16384
ds_read_b64_tr_b16 v[50:51], v42 offset:17408
s_waitcnt lgkmcnt(8)
v_mfma_f32_32x32x16_bf16 v[80:95], v[56:59], v[60:63], v[80:95]
ds_read_b64_tr_b16 v[56:57], v42 offset:20480
ds_read_b64_tr_b16 v[58:59], v42 offset:21504
s_waitcnt lgkmcnt(7)
v_mfma_f32_32x32x16_bf16 v[80:95], v[64:67], v[68:71], v[80:95]
ds_read_b64_tr_b16 v[64:65], v42 offset:24576
ds_read_b64_tr_b16 v[66:67], v42 offset:25600
s_waitcnt lgkmcnt(6)
v_mfma_f32_32x32x16_bf16 v[80:95], v[72:75], v[76:79], v[80:95]
ds_read_b64_tr_b16 v[72:73], v42 offset:28672
ds_read_b64_tr_b16 v[74:75], v42 offset:29696
s_nop 9
v_mul_f32 v80, v44, v80
v_mul_f32 v81, v44, v81
v_mul_f32 v82, v44, v82
v_mul_f32 v83, v44, v83
v_mul_f32 v84, v44, v84
v_mul_f32 v85, v44, v85
v_mul_f32 v86, v44, v86
v_mul_f32 v87, v44, v87
v_mul_f32 v88, v44, v88
v_mul_f32 v89, v44, v89
v_mul_f32 v90, v44, v90
v_mul_f32 v91, v44, v91
v_mul_f32 v92, v44, v92
v_mul_f32 v93, v44, v93
v_mul_f32 v94, v44, v94
v_mul_f32 v95, v44, v95
s_barrier
s_waitcnt lgkmcnt(6)
v_mfma_f32_32x32x16_bf16 v[80:95], v[96:99], v[48:51], v[80:95]
ds_read_b64_tr_b16 v[48:49], v42 offset:32768
ds_read_b64_tr_b16 v[50:51], v42 offset:33792
s_waitcnt lgkmcnt(6)
v_mfma_f32_32x32x16_bf16 v[80:95], v[100:103], v[56:59], v[80:95]
ds_read_b64_tr_b16 v[56:57], v42 offset:36864
ds_read_b64_tr_b16 v[58:59], v42 offset:37888
s_waitcnt lgkmcnt(6)
v_mfma_f32_32x32x16_bf16 v[80:95], v[104:107], v[64:67], v[80:95]
ds_read_b64_tr_b16 v[64:65], v42 offset:40960
ds_read_b64_tr_b16 v[66:67], v42 offset:41984
s_waitcnt lgkmcnt(6)
v_mfma_f32_32x32x16_bf16 v[80:95], v[108:111], v[72:75], v[80:95]
ds_read_b64_tr_b16 v[72:73], v42 offset:45056
ds_read_b64_tr_b16 v[74:75], v42 offset:46080
s_barrier
s_waitcnt lgkmcnt(6)
v_mfma_f32_32x32x16_bf16 v[80:95], v[112:115], v[48:51], v[80:95]
ds_read_b64_tr_b16 v[48:49], v42 offset:49152
ds_read_b64_tr_b16 v[50:51], v42 offset:50176
s_waitcnt lgkmcnt(6)
v_mfma_f32_32x32x16_bf16 v[80:95], v[116:119], v[56:59], v[80:95]
ds_read_b64_tr_b16 v[56:57], v42 offset:53248
ds_read_b64_tr_b16 v[58:59], v42 offset:54272
s_waitcnt lgkmcnt(6)
v_mfma_f32_32x32x16_bf16 v[80:95], v[120:123], v[64:67], v[80:95]
ds_read_b64_tr_b16 v[64:65], v42 offset:57344
ds_read_b64_tr_b16 v[66:67], v42 offset:58368
s_waitcnt lgkmcnt(6)
v_mfma_f32_32x32x16_bf16 v[80:95], v[124:127], v[72:75], v[80:95]
ds_read_b64_tr_b16 v[72:73], v42 offset:61440
ds_read_b64_tr_b16 v[74:75], v42 offset:62464
s_barrier
s_waitcnt lgkmcnt(6)
v_mfma_f32_32x32x16_bf16 v[80:95], v[128:131], v[48:51], v[80:95]
ds_read_b64_tr_b16 v[48:49], v38 offset:0
ds_read_b64_tr_b16 v[50:51], v38 offset:1024
s_waitcnt lgkmcnt(6)
v_mfma_f32_32x32x16_bf16 v[80:95], v[132:135], v[56:59], v[80:95]
ds_read_b64_tr_b16 v[56:57], v38 offset:4096
ds_read_b64_tr_b16 v[58:59], v38 offset:5120
s_waitcnt lgkmcnt(6)
v_mfma_f32_32x32x16_bf16 v[80:95], v[136:139], v[64:67], v[80:95]
ds_read_b64_tr_b16 v[64:65], v38 offset:8192
ds_read_b64_tr_b16 v[66:67], v38 offset:9216
s_waitcnt lgkmcnt(6)
v_mfma_f32_32x32x16_bf16 v[80:95], v[140:143], v[72:75], v[80:95]
ds_read_b64_tr_b16 v[72:73], v38 offset:12288
ds_read_b64_tr_b16 v[74:75], v38 offset:13312
s_barrier
s_waitcnt lgkmcnt(6)
v_mfma_f32_32x32x16_bf16 v[80:95], v[144:147], v[48:51], v[80:95]
ds_read_b64_tr_b16 v[48:49], v38 offset:16384
ds_read_b64_tr_b16 v[50:51], v38 offset:17408
s_waitcnt lgkmcnt(6)
v_mfma_f32_32x32x16_bf16 v[80:95], v[148:151], v[56:59], v[80:95]
ds_read_b64_tr_b16 v[56:57], v38 offset:20480
ds_read_b64_tr_b16 v[58:59], v38 offset:21504
s_waitcnt lgkmcnt(6)
v_mfma_f32_32x32x16_bf16 v[80:95], v[152:155], v[64:67], v[80:95]
ds_read_b64_tr_b16 v[64:65], v38 offset:24576
ds_read_b64_tr_b16 v[66:67], v38 offset:25600
s_waitcnt lgkmcnt(6)
v_mfma_f32_32x32x16_bf16 v[80:95], v[156:159], v[72:75], v[80:95]
ds_read_b64_tr_b16 v[72:73], v38 offset:28672
ds_read_b64_tr_b16 v[74:75], v38 offset:29696
s_barrier
s_waitcnt lgkmcnt(6)
v_mfma_f32_32x32x16_bf16 v[80:95], v[160:163], v[48:51], v[80:95]
ds_read_b64_tr_b16 v[48:49], v38 offset:32768
ds_read_b64_tr_b16 v[50:51], v38 offset:33792
s_waitcnt lgkmcnt(6)
v_mfma_f32_32x32x16_bf16 v[80:95], v[164:167], v[56:59], v[80:95]
ds_read_b64_tr_b16 v[56:57], v38 offset:36864
ds_read_b64_tr_b16 v[58:59], v38 offset:37888
s_waitcnt lgkmcnt(6)
v_mfma_f32_32x32x16_bf16 v[80:95], v[168:171], v[64:67], v[80:95]
ds_read_b64_tr_b16 v[64:65], v38 offset:40960
ds_read_b64_tr_b16 v[66:67], v38 offset:41984
s_waitcnt lgkmcnt(6)
v_mfma_f32_32x32x16_bf16 v[80:95], v[172:175], v[72:75], v[80:95]
ds_read_b64_tr_b16 v[72:73], v38 offset:45056
ds_read_b64_tr_b16 v[74:75], v38 offset:46080
s_barrier
s_waitcnt lgkmcnt(6)
v_mfma_f32_32x32x16_bf16 v[80:95], v[176:179], v[48:51], v[80:95]
ds_read_b64_tr_b16 v[48:49], v42 offset:0
ds_read_b64_tr_b16 v[50:51], v42 offset:1024
s_waitcnt lgkmcnt(6)
v_mfma_f32_32x32x16_bf16 v[80:95], v[180:183], v[56:59], v[80:95]
ds_read_b64_tr_b16 v[56:57], v42 offset:4096
ds_read_b64_tr_b16 v[58:59], v42 offset:5120
s_waitcnt lgkmcnt(6)
v_mfma_f32_32x32x16_bf16 v[80:95], v[184:187], v[64:67], v[80:95]
ds_read_b64_tr_b16 v[64:65], v42 offset:8192
ds_read_b64_tr_b16 v[66:67], v42 offset:9216
s_waitcnt lgkmcnt(6)
v_mfma_f32_32x32x16_bf16 v[80:95], v[188:191], v[72:75], v[80:95]
ds_read_b64_tr_b16 v[72:73], v42 offset:12288
ds_read_b64_tr_b16 v[74:75], v42 offset:13312
s_barrier
s_waitcnt lgkmcnt(6)
v_mfma_f32_32x32x16_bf16 v[80:95], v[192:195], v[48:51], v[80:95]
ds_read_b64_tr_b16 v[48:49], v42 offset:16384
ds_read_b64_tr_b16 v[50:51], v42 offset:17408
s_waitcnt lgkmcnt(6)
v_mfma_f32_32x32x16_bf16 v[80:95], v[196:199], v[56:59], v[80:95]
ds_read_b64_tr_b16 v[56:57], v42 offset:20480
ds_read_b64_tr_b16 v[58:59], v42 offset:21504
s_waitcnt lgkmcnt(6)
v_mfma_f32_32x32x16_bf16 v[80:95], v[200:203], v[64:67], v[80:95]
ds_read_b64_tr_b16 v[64:65], v42 offset:24576
ds_read_b64_tr_b16 v[66:67], v42 offset:25600
s_waitcnt lgkmcnt(6)
v_mfma_f32_32x32x16_bf16 v[80:95], v[204:207], v[72:75], v[80:95]
ds_read_b64_tr_b16 v[72:73], v42 offset:28672
ds_read_b64_tr_b16 v[74:75], v42 offset:29696
s_waitcnt lgkmcnt(6)
v_mfma_f32_32x32x16_bf16 v[80:95], v[208:211], v[48:51], v[80:95]
s_waitcnt lgkmcnt(4)
v_mfma_f32_32x32x16_bf16 v[80:95], v[212:215], v[56:59], v[80:95]
s_waitcnt lgkmcnt(2)
v_mfma_f32_32x32x16_bf16 v[80:95], v[216:219], v[64:67], v[80:95]
s_waitcnt lgkmcnt(0)
v_mfma_f32_32x32x16_bf16 v[80:95], v[220:223], v[72:75], v[80:95]
s_barrier
s_lshl_b32 s56, s46, 5
v_add_u32 v2, s56, v9
v_mul_u32_u24 v2, 272, v2
s_lshl_b32 s56, s45, 7
v_lshl_add_u32 v2, v10, 6, v2
v_add_u32 v2, s56, v2
s_nop 4
ds_write_b128 v2, v[80:83] offset:0
ds_write_b128 v2, v[84:87] offset:16
ds_write_b128 v2, v[88:91] offset:32
ds_write_b128 v2, v[92:95] offset:48
s_waitcnt lgkmcnt(0)
s_barrier
ds_read_b128 v[24:27], v13
ds_read_b128 v[28:31], v13 offset:16
s_waitcnt vmcnt(0) lgkmcnt(0)
v_lshlrev_b32 v2, 16, v16
v_and_b32 v3, 0xffff0000, v16
v_add_f32 v2, v2, v24
v_add_f32 v3, v3, v25
v_cvt_pk_bf16_f32 v16, v2, v3
v_lshlrev_b32 v2, 16, v17
v_and_b32 v3, 0xffff0000, v17
v_add_f32 v2, v2, v26
v_add_f32 v3, v3, v27
v_cvt_pk_bf16_f32 v17, v2, v3
v_lshlrev_b32 v2, 16, v18
v_and_b32 v3, 0xffff0000, v18
v_add_f32 v2, v2, v28
v_add_f32 v3, v3, v29
v_cvt_pk_bf16_f32 v18, v2, v3
v_lshlrev_b32 v2, 16, v19
v_and_b32 v3, 0xffff0000, v19
v_add_f32 v2, v2, v30
v_add_f32 v3, v3, v31
v_cvt_pk_bf16_f32 v19, v2, v3
buffer_store_dwordx4 v[16:19], v12, s[28:31], 0 offen
L_done:
s_endpgm
L_code_end:
s_endpgm
.section .rodata,"a"
.p2align 6
.amdhsa_kernel parallel_sum__spectral_gfnet__glu_gated_reglu__prompt_kernel
  .amdhsa_next_free_vgpr 256
  .amdhsa_next_free_sgpr 102
  .amdhsa_accum_offset 256
  .amdhsa_group_segment_fixed_size 0
  .amdhsa_kernarg_size 80
  .amdhsa_user_sgpr_count 2
  .amdhsa_user_sgpr_kernarg_segment_ptr 1
  .amdhsa_system_sgpr_workgroup_id_x 1
.end_amdhsa_kernel
```
